```python
import torch

def _softmax(x, axis=-1):
    return torch.softmax(x, dim=axis)
def _gelu(x):
    return torch.nn.functional.gelu(x, approximate="tanh")
def _silu(x):
    return torch.nn.functional.silu(x)
def _sigmoid(x):
    return torch.sigmoid(x)
def _layernorm(x, axis=-1, eps=1e-5):
    m = x.mean(dim=axis, keepdim=True)
    v = x.var(dim=axis, keepdim=True, unbiased=False)
    return (x - m) / torch.sqrt(v + eps)
def _scatter_add(tgt, idx, src, axis=0):
    return tgt.clone().index_add_(axis, idx, src)
def _segment_sum(src, seg, n):
    out = torch.zeros((n,) + src.shape[1:], dtype=src.dtype)
    return out.index_add_(0, seg, src)
def _pad(x, pw):
    flat = tuple(v for pair in reversed(pw) for v in pair)
    return torch.nn.functional.pad(x, flat)

kernel_name = 'concat_heads__mha_block_cached__compressed_kv_cla__decode'

def setup_inputs():

    _w = (lambda a: (lambda t: t.to(torch.bfloat16) if t.is_floating_point() else t)(torch.as_tensor(a)))
    def _A_setup():
        B, Sq, D = 2, 1, 448
        H, Sk, Dh = 16, 4096, 256
        return {
            "x": _w((lambda *s: torch.randn(*s, dtype=torch.bfloat16) * 1.6)(B, Sq, D)),
            "k_cache": _w((lambda *s: torch.randn(*s, dtype=torch.bfloat16) * 1.6)(B, H, Sk, Dh)),
            "v_cache": _w((lambda *s: torch.randn(*s, dtype=torch.bfloat16) * 0.05)(B, H, Sk, Dh)),
            "wq": _w((lambda *s: torch.randn(*s, dtype=torch.bfloat16) * 1.6)(D, H * Dh) * (D ** -0.5)),
            "wo": _w((lambda *s: torch.randn(*s, dtype=torch.bfloat16) * 0.05)(H * Dh, D) * ((H * Dh) ** -0.5)),
        }
    _A_in = _A_setup()

    def _B_setup():
        B, H, Sq, Sk, D, M = 2, 16, 1, 4096, 256, 448
        Dc = 4 * D
        return {
            "x": _w((lambda *s: torch.randn(*s, dtype=torch.bfloat16) * 3.2)(B, Sq, M)),
            "c_kv": _w((lambda *s: torch.randn(*s, dtype=torch.bfloat16) * 0.1)(B, Sk, Dc)),
            "w_q": _w((lambda *s: torch.randn(*s, dtype=torch.bfloat16) * 6.4)(M, H, D) * (M ** -0.5)),
            "w_uk": _w((lambda *s: torch.randn(*s, dtype=torch.bfloat16) * 6.4)(Dc, H, D) * (Dc ** -0.5)),
            "w_uv": _w((lambda *s: torch.randn(*s, dtype=torch.bfloat16) * 0.1)(Dc, H, D) * (Dc ** -0.5)),
            "w_o": _w((lambda *s: torch.randn(*s, dtype=torch.bfloat16) * 0.1)(H, D, M) * ((H * D) ** -0.5)),
        }
    _B_in = _B_setup()

    return {
        "A_x": _A_in["x"],
        "A_k_cache": _A_in["k_cache"],
        "A_v_cache": _A_in["v_cache"],
        "A_wq": _A_in["wq"],
        "A_wo": _A_in["wo"],
        "B_x": _B_in["x"],
        "B_c_kv": _B_in["c_kv"],
        "B_w_q": _B_in["w_q"],
        "B_w_uk": _B_in["w_uk"],
        "B_w_uv": _B_in["w_uv"],
        "B_w_o": _B_in["w_o"],
    }

def reference(A_x, A_k_cache, A_v_cache, A_wq, A_wo, B_x, B_c_kv, B_w_q, B_w_uk, B_w_uv, B_w_o):
    def _A_ref(x, k_cache, v_cache, wq, wo):
        B, Sq, D = x.shape
        H, Dh = 16, 256
        q = (lambda x, *d: x.permute(*d))((x @ wq).reshape(B, Sq, H, Dh), 0, 2, 1, 3)
        scores = torch.einsum("bhqd,bhkd->bhqk", q, k_cache) * (Dh ** -0.5)
        p = _softmax(scores, axis=-1)
        o = torch.einsum("bhqk,bhkd->bhqd", p, v_cache)
        return (lambda x, *d: x.permute(*d))(o, 0, 2, 1, 3).reshape(B, Sq, H * Dh) @ wo

    def _B_ref(x, c_kv, w_q, w_uk, w_uv, w_o):
        B, Sq, M = x.shape[0], x.shape[1], x.shape[2]
        Sk = c_kv.shape[1]
        H, D = w_q.shape[1], w_q.shape[2]
        q = torch.einsum("bqm,mhd->bhqd", x, w_q)
        k = torch.einsum("bkc,chd->bhkd", c_kv, w_uk)
        v = torch.einsum("bkc,chd->bhkd", c_kv, w_uv)
        scores = torch.einsum("bhqd,bhkd->bhqk", q, k) * (D ** -0.5)
        off = Sk - Sq
        qi = torch.arange(Sq)[:, None]
        kj = torch.arange(Sk)[None, :]
        cmask = kj <= (qi + off)
        scores = torch.where(cmask[None, None], scores, -1e9)
        p = _softmax(scores, axis=-1)
        ctx = torch.einsum("bhqk,bhkd->bhqd", p, v)
        return torch.einsum("bhqd,hdm->bqm", ctx, w_o)

    a = _A_ref(A_x, A_k_cache, A_v_cache, A_wq, A_wo)
    b = _B_ref(B_x, B_c_kv, B_w_q, B_w_uk, B_w_uv, B_w_o)
    return torch.concatenate([a, b], axis=-1)
```

```asm
; @launch grid=(256,1,1) block=(512,1,1) lds=150528
.amdgcn_target "amdgcn-amd-amdhsa--gfx950"
.text
.globl concat_heads__mha_block_cached__compressed_kv_cla__decode_kernel
.p2align 8
.type concat_heads__mha_block_cached__compressed_kv_cla__decode_kernel,@function
concat_heads__mha_block_cached__compressed_kv_cla__decode_kernel:
    s_cmp_ge_u32 s2, 256
    s_cbranch_scc1 L_END
    s_and_b32 s96, s2, 7
    s_lshr_b32 s97, s2, 3
    s_mul_i32 s98, s96, 24
    s_add_u32 s98, s98, s97
    s_lshl_b32 s99, s96, 3
    s_add_u32 s99, s99, s97
    s_add_u32 s99, s99, 168
    s_cmp_lt_u32 s97, 24
    s_cselect_b32 s2, s98, s99
    s_load_dwordx16 s[8:23], s[0:1], 0
    s_load_dwordx8 s[24:31], s[0:1], 64
    s_load_dwordx4 s[32:35], s[0:1], 96
    v_and_b32 v1, 63, v0
    v_lshrrev_b32 v12, 6, v0
    v_and_b32 v2, 15, v0
    v_bfe_u32 v3, v0, 4, 2
    v_readfirstlane_b32 s3, v12
    v_mov_b32 v4, 0
    v_mov_b32 v5, 0
    s_mov_b32 s72, 0x05040100
    s_mov_b32 s73, 0x07060302
    s_mov_b32 s74, 0x3fb8aa3b
    s_mov_b32 s76, 0x00010001
    s_mov_b32 s77, 0x00010001
    s_mul_i32 s96, s2, 43691
    s_lshr_b32 s96, s96, 19
    s_mul_i32 s97, s96, 12
    s_sub_u32 s97, s2, s97
    s_cmp_ge_u32 s97, 8
    s_cselect_b32 s99, 1, 0
    s_cmp_ge_u32 s2, 192
    s_cselect_b32 s99, 1, s99
    s_cmp_eq_u32 s99, 0
    s_waitcnt lgkmcnt(0)
    s_cselect_b32 s36, s8, s18
    s_cselect_b32 s37, s9, s19
    s_mov_b32 s38, 1792
    s_mov_b32 s39, 0x00020000
    s_cselect_b32 s40, s14, s22
    s_cselect_b32 s41, s15, s23
    s_mov_b32 s42, 3670016
    s_mov_b32 s43, 0x00020000
    s_cmp_lt_u32 s2, 192
    s_cselect_b32 s44, s24, s28
    s_cselect_b32 s45, s25, s29
    s_mov_b32 s98, 8388608
    s_cselect_b32 s46, s98, 3670016
    s_mov_b32 s47, 0x00020000
    s_cselect_b32 s48, s10, s20
    s_cselect_b32 s49, s11, s21
    s_mov_b32 s98, 67108864
    s_cselect_b32 s50, s98, 16777216
    s_mov_b32 s51, 0x00020000
    s_cselect_b32 s52, s12, s26
    s_cselect_b32 s53, s13, s27
    s_mov_b32 s98, 67108864
    s_cselect_b32 s54, s98, 8388608
    s_mov_b32 s55, 0x00020000
    s_cselect_b32 s60, s34, s34
    s_cselect_b32 s61, s35, s35
    s_mov_b32 s62, 268435456
    s_mov_b32 s63, 0x00020000
    s_cselect_b32 s64, s30, s30
    s_cselect_b32 s65, s31, s31
    s_mov_b32 s66, 3584
    s_mov_b32 s67, 0x00020000
    s_cselect_b32 s68, s16, s16
    s_cselect_b32 s69, s17, s17
    s_mov_b32 s70, 3670016
    s_mov_b32 s71, 0x00020000
    s_cselect_b32 s16, 1, 0
    s_cselect_b32 s30, 0, 1
    s_mov_b32 s31, s99
    buffer_load_dword v127, off, s[60:63], 0 sc1
    s_cbranch_scc0 L_ROLE_B0
    s_mov_b32 s6, s97
    s_mov_b32 s5, s96
    s_mov_b32 s7, s2
    s_cmp_ge_u32 s6, 6
    s_cselect_b32 s24, 1, 0
    s_mul_i32 s99, s24, 6
    s_sub_u32 s98, s6, s99
    s_mov_b32 s25, s98
    s_mul_i32 s99, s98, 8388672
    s_lshr_b32 s99, s99, 17
    s_add_u32 s98, s98, 1
    s_mul_i32 s98, s98, 8388672
    s_lshr_b32 s19, s98, 17
    s_lshl_b32 s98, s24, 4
    s_add_u32 s98, s98, s5
    s_lshl_b32 s26, s98, 8
    s_add_u32 s26, s26, 819200
    s_lshl_b32 s20, s98, 21
    s_add_u32 s100, s99, s3
    s_lshl_b32 s100, s100, 12
    s_add_u32 s17, s20, s100
    v_lshlrev_b32 v4, 10, v3
    v_lshl_add_u32 v4, v2, 4, v4
    s_add_u32 s99, s99, 8
    v_mov_b32 v5, 149504
    v_mov_b32 v6, s99
    v_mov_b32 v7, 0
    ds_write_b64 v5, v[6:7]
    s_and_b32 s8, s6, 3
    s_cmp_ge_u32 s6, 4
    s_cselect_b32 s9, 1, 0
    s_cmp_ge_u32 s6, 8
    s_cselect_b32 s9, 0, s9
    s_cmp_ge_u32 s3, 1
    s_cbranch_scc1 NOQ_1
    s_cmp_lg_u32 s25, 0
    s_cbranch_scc1 NOZ_3
    s_mov_b64 exec, 1
    buffer_store_dword v7, off, s[60:63], s26 sc1
    s_mov_b64 exec, -1
NOZ_3:
    s_mul_i32 s12, s8, 224
    s_add_u32 s13, s12, 896
    s_mul_i32 s10, s8, 917504
    s_lshl_b32 s11, s5, 9
    s_add_u32 s10, s10, s11
    s_lshl_b32 s11, s9, 8
    s_add_u32 s10, s10, s11
    s_mov_b32 s14, 229376
    v_mul_lo_u32 v12, v3, s14
    v_lshl_add_u32 v12, v2, 4, v12
    v_mul_u32_u24 v13, 56, v3
    buffer_load_dwordx4 v[56:59], v13, s[36:39], s12 offen
    buffer_load_dwordx4 v[60:63], v13, s[36:39], s12 offen offset:16
    buffer_load_dwordx4 v[64:67], v13, s[36:39], s12 offen offset:32
    buffer_load_dwordx2 v[68:69], v13, s[36:39], s12 offen offset:48
    buffer_load_dwordx4 v[70:73], v13, s[36:39], s13 offen
    buffer_load_dwordx4 v[74:77], v13, s[36:39], s13 offen offset:16
    buffer_load_dwordx4 v[78:81], v13, s[36:39], s13 offen offset:32
    buffer_load_dwordx2 v[82:83], v13, s[36:39], s13 offen offset:48
    buffer_load_dwordx4 v[128:131], v12, s[40:43], s10 offen nt
    s_add_u32 s10, s10, 8192
    buffer_load_dwordx4 v[132:135], v12, s[40:43], s10 offen nt
    s_add_u32 s10, s10, 8192
    buffer_load_dwordx4 v[136:139], v12, s[40:43], s10 offen nt
    s_add_u32 s10, s10, 8192
    buffer_load_dwordx4 v[140:143], v12, s[40:43], s10 offen nt
    s_add_u32 s10, s10, 8192
    buffer_load_dwordx4 v[144:147], v12, s[40:43], s10 offen nt
    s_add_u32 s10, s10, 8192
    buffer_load_dwordx4 v[148:151], v12, s[40:43], s10 offen nt
    s_add_u32 s10, s10, 8192
    buffer_load_dwordx4 v[152:155], v12, s[40:43], s10 offen nt
    s_add_u32 s10, s10, 8192
    buffer_load_dwordx4 v[156:159], v12, s[40:43], s10 offen nt
    s_add_u32 s10, s10, 8192
    buffer_load_dwordx4 v[160:163], v12, s[40:43], s10 offen nt
    s_add_u32 s10, s10, 8192
    buffer_load_dwordx4 v[164:167], v12, s[40:43], s10 offen nt
    s_add_u32 s10, s10, 8192
    buffer_load_dwordx4 v[168:171], v12, s[40:43], s10 offen nt
    s_add_u32 s10, s10, 8192
    buffer_load_dwordx4 v[172:175], v12, s[40:43], s10 offen nt
    s_add_u32 s10, s10, 8192
    buffer_load_dwordx4 v[176:179], v12, s[40:43], s10 offen nt
    s_add_u32 s10, s10, 8192
    buffer_load_dwordx4 v[180:183], v12, s[40:43], s10 offen nt
    s_add_u32 s10, s10, 8192
    buffer_load_dwordx4 v[184:187], v12, s[40:43], s10 offen nt
    s_add_u32 s10, s10, 8192
    buffer_load_dwordx4 v[188:191], v12, s[40:43], s10 offen nt
    s_add_u32 s10, s10, 8192
    buffer_load_dwordx4 v[192:195], v12, s[40:43], s10 offen nt
    s_add_u32 s10, s10, 8192
    buffer_load_dwordx4 v[196:199], v12, s[40:43], s10 offen nt
    s_add_u32 s10, s10, 8192
    buffer_load_dwordx4 v[200:203], v12, s[40:43], s10 offen nt
    s_add_u32 s10, s10, 8192
    buffer_load_dwordx4 v[204:207], v12, s[40:43], s10 offen nt
    s_add_u32 s10, s10, 8192
    buffer_load_dwordx4 v[208:211], v12, s[40:43], s10 offen nt
    s_add_u32 s10, s10, 8192
    buffer_load_dwordx4 v[212:215], v12, s[40:43], s10 offen nt
    s_add_u32 s10, s10, 8192
    buffer_load_dwordx4 v[216:219], v12, s[40:43], s10 offen nt
    s_add_u32 s10, s10, 8192
    buffer_load_dwordx4 v[220:223], v12, s[40:43], s10 offen nt
    s_add_u32 s10, s10, 8192
    buffer_load_dwordx4 v[224:227], v12, s[40:43], s10 offen nt
    s_add_u32 s10, s10, 8192
    buffer_load_dwordx4 v[228:231], v12, s[40:43], s10 offen nt
    s_add_u32 s10, s10, 8192
    buffer_load_dwordx4 v[232:235], v12, s[40:43], s10 offen nt
    s_add_u32 s10, s10, 8192
    buffer_load_dwordx4 v[236:239], v12, s[40:43], s10 offen nt
    s_add_u32 s10, s10, 8192
    v_mov_b32 v32, 0
    v_mov_b32 v33, 0
    v_mov_b32 v34, 0
    v_mov_b32 v35, 0
    v_mov_b32 v36, 0
    v_mov_b32 v37, 0
    v_mov_b32 v38, 0
    v_mov_b32 v39, 0
    v_mov_b32 v40, 0
    v_mov_b32 v41, 0
    v_mov_b32 v42, 0
    v_mov_b32 v43, 0
    v_mov_b32 v44, 0
    v_mov_b32 v45, 0
    v_mov_b32 v46, 0
    v_mov_b32 v47, 0
    s_waitcnt vmcnt(26)
    v_perm_b32 v48, v132, v128, s72
    v_perm_b32 v49, v132, v128, s73
    v_perm_b32 v50, v133, v129, s72
    v_perm_b32 v51, v133, v129, s73
    v_perm_b32 v52, v134, v130, s72
    v_perm_b32 v53, v134, v130, s73
    v_perm_b32 v54, v135, v131, s72
    v_perm_b32 v55, v135, v131, s73
    v_dot2_f32_bf16 v32, v48, v56, v32
    v_dot2_f32_bf16 v33, v49, v56, v33
    v_dot2_f32_bf16 v34, v50, v56, v34
    v_dot2_f32_bf16 v35, v51, v56, v35
    v_dot2_f32_bf16 v36, v52, v56, v36
    v_dot2_f32_bf16 v37, v53, v56, v37
    v_dot2_f32_bf16 v38, v54, v56, v38
    v_dot2_f32_bf16 v39, v55, v56, v39
    v_dot2_f32_bf16 v40, v48, v70, v40
    v_dot2_f32_bf16 v41, v49, v70, v41
    v_dot2_f32_bf16 v42, v50, v70, v42
    v_dot2_f32_bf16 v43, v51, v70, v43
    v_dot2_f32_bf16 v44, v52, v70, v44
    v_dot2_f32_bf16 v45, v53, v70, v45
    v_dot2_f32_bf16 v46, v54, v70, v46
    v_dot2_f32_bf16 v47, v55, v70, v47
    s_waitcnt vmcnt(24)
    v_perm_b32 v48, v140, v136, s72
    v_perm_b32 v49, v140, v136, s73
    v_perm_b32 v50, v141, v137, s72
    v_perm_b32 v51, v141, v137, s73
    v_perm_b32 v52, v142, v138, s72
    v_perm_b32 v53, v142, v138, s73
    v_perm_b32 v54, v143, v139, s72
    v_perm_b32 v55, v143, v139, s73
    v_dot2_f32_bf16 v32, v48, v57, v32
    v_dot2_f32_bf16 v33, v49, v57, v33
    v_dot2_f32_bf16 v34, v50, v57, v34
    v_dot2_f32_bf16 v35, v51, v57, v35
    v_dot2_f32_bf16 v36, v52, v57, v36
    v_dot2_f32_bf16 v37, v53, v57, v37
    v_dot2_f32_bf16 v38, v54, v57, v38
    v_dot2_f32_bf16 v39, v55, v57, v39
    v_dot2_f32_bf16 v40, v48, v71, v40
    v_dot2_f32_bf16 v41, v49, v71, v41
    v_dot2_f32_bf16 v42, v50, v71, v42
    v_dot2_f32_bf16 v43, v51, v71, v43
    v_dot2_f32_bf16 v44, v52, v71, v44
    v_dot2_f32_bf16 v45, v53, v71, v45
    v_dot2_f32_bf16 v46, v54, v71, v46
    v_dot2_f32_bf16 v47, v55, v71, v47
    s_waitcnt vmcnt(22)
    v_perm_b32 v48, v148, v144, s72
    v_perm_b32 v49, v148, v144, s73
    v_perm_b32 v50, v149, v145, s72
    v_perm_b32 v51, v149, v145, s73
    v_perm_b32 v52, v150, v146, s72
    v_perm_b32 v53, v150, v146, s73
    v_perm_b32 v54, v151, v147, s72
    v_perm_b32 v55, v151, v147, s73
    v_dot2_f32_bf16 v32, v48, v58, v32
    v_dot2_f32_bf16 v33, v49, v58, v33
    v_dot2_f32_bf16 v34, v50, v58, v34
    v_dot2_f32_bf16 v35, v51, v58, v35
    v_dot2_f32_bf16 v36, v52, v58, v36
    v_dot2_f32_bf16 v37, v53, v58, v37
    v_dot2_f32_bf16 v38, v54, v58, v38
    v_dot2_f32_bf16 v39, v55, v58, v39
    v_dot2_f32_bf16 v40, v48, v72, v40
    v_dot2_f32_bf16 v41, v49, v72, v41
    v_dot2_f32_bf16 v42, v50, v72, v42
    v_dot2_f32_bf16 v43, v51, v72, v43
    v_dot2_f32_bf16 v44, v52, v72, v44
    v_dot2_f32_bf16 v45, v53, v72, v45
    v_dot2_f32_bf16 v46, v54, v72, v46
    v_dot2_f32_bf16 v47, v55, v72, v47
    s_waitcnt vmcnt(20)
    v_perm_b32 v48, v156, v152, s72
    v_perm_b32 v49, v156, v152, s73
    v_perm_b32 v50, v157, v153, s72
    v_perm_b32 v51, v157, v153, s73
    v_perm_b32 v52, v158, v154, s72
    v_perm_b32 v53, v158, v154, s73
    v_perm_b32 v54, v159, v155, s72
    v_perm_b32 v55, v159, v155, s73
    v_dot2_f32_bf16 v32, v48, v59, v32
    v_dot2_f32_bf16 v33, v49, v59, v33
    v_dot2_f32_bf16 v34, v50, v59, v34
    v_dot2_f32_bf16 v35, v51, v59, v35
    v_dot2_f32_bf16 v36, v52, v59, v36
    v_dot2_f32_bf16 v37, v53, v59, v37
    v_dot2_f32_bf16 v38, v54, v59, v38
    v_dot2_f32_bf16 v39, v55, v59, v39
    v_dot2_f32_bf16 v40, v48, v73, v40
    v_dot2_f32_bf16 v41, v49, v73, v41
    v_dot2_f32_bf16 v42, v50, v73, v42
    v_dot2_f32_bf16 v43, v51, v73, v43
    v_dot2_f32_bf16 v44, v52, v73, v44
    v_dot2_f32_bf16 v45, v53, v73, v45
    v_dot2_f32_bf16 v46, v54, v73, v46
    v_dot2_f32_bf16 v47, v55, v73, v47
    s_waitcnt vmcnt(18)
    v_perm_b32 v48, v164, v160, s72
    v_perm_b32 v49, v164, v160, s73
    v_perm_b32 v50, v165, v161, s72
    v_perm_b32 v51, v165, v161, s73
    v_perm_b32 v52, v166, v162, s72
    v_perm_b32 v53, v166, v162, s73
    v_perm_b32 v54, v167, v163, s72
    v_perm_b32 v55, v167, v163, s73
    v_dot2_f32_bf16 v32, v48, v60, v32
    v_dot2_f32_bf16 v33, v49, v60, v33
    v_dot2_f32_bf16 v34, v50, v60, v34
    v_dot2_f32_bf16 v35, v51, v60, v35
    v_dot2_f32_bf16 v36, v52, v60, v36
    v_dot2_f32_bf16 v37, v53, v60, v37
    v_dot2_f32_bf16 v38, v54, v60, v38
    v_dot2_f32_bf16 v39, v55, v60, v39
    v_dot2_f32_bf16 v40, v48, v74, v40
    v_dot2_f32_bf16 v41, v49, v74, v41
    v_dot2_f32_bf16 v42, v50, v74, v42
    v_dot2_f32_bf16 v43, v51, v74, v43
    v_dot2_f32_bf16 v44, v52, v74, v44
    v_dot2_f32_bf16 v45, v53, v74, v45
    v_dot2_f32_bf16 v46, v54, v74, v46
    v_dot2_f32_bf16 v47, v55, v74, v47
    s_waitcnt vmcnt(16)
    v_perm_b32 v48, v172, v168, s72
    v_perm_b32 v49, v172, v168, s73
    v_perm_b32 v50, v173, v169, s72
    v_perm_b32 v51, v173, v169, s73
    v_perm_b32 v52, v174, v170, s72
    v_perm_b32 v53, v174, v170, s73
    v_perm_b32 v54, v175, v171, s72
    v_perm_b32 v55, v175, v171, s73
    v_dot2_f32_bf16 v32, v48, v61, v32
    v_dot2_f32_bf16 v33, v49, v61, v33
    v_dot2_f32_bf16 v34, v50, v61, v34
    v_dot2_f32_bf16 v35, v51, v61, v35
    v_dot2_f32_bf16 v36, v52, v61, v36
    v_dot2_f32_bf16 v37, v53, v61, v37
    v_dot2_f32_bf16 v38, v54, v61, v38
    v_dot2_f32_bf16 v39, v55, v61, v39
    v_dot2_f32_bf16 v40, v48, v75, v40
    v_dot2_f32_bf16 v41, v49, v75, v41
    v_dot2_f32_bf16 v42, v50, v75, v42
    v_dot2_f32_bf16 v43, v51, v75, v43
    v_dot2_f32_bf16 v44, v52, v75, v44
    v_dot2_f32_bf16 v45, v53, v75, v45
    v_dot2_f32_bf16 v46, v54, v75, v46
    v_dot2_f32_bf16 v47, v55, v75, v47
    s_waitcnt vmcnt(14)
    v_perm_b32 v48, v180, v176, s72
    v_perm_b32 v49, v180, v176, s73
    v_perm_b32 v50, v181, v177, s72
    v_perm_b32 v51, v181, v177, s73
    v_perm_b32 v52, v182, v178, s72
    v_perm_b32 v53, v182, v178, s73
    v_perm_b32 v54, v183, v179, s72
    v_perm_b32 v55, v183, v179, s73
    v_dot2_f32_bf16 v32, v48, v62, v32
    v_dot2_f32_bf16 v33, v49, v62, v33
    v_dot2_f32_bf16 v34, v50, v62, v34
    v_dot2_f32_bf16 v35, v51, v62, v35
    v_dot2_f32_bf16 v36, v52, v62, v36
    v_dot2_f32_bf16 v37, v53, v62, v37
    v_dot2_f32_bf16 v38, v54, v62, v38
    v_dot2_f32_bf16 v39, v55, v62, v39
    v_dot2_f32_bf16 v40, v48, v76, v40
    v_dot2_f32_bf16 v41, v49, v76, v41
    v_dot2_f32_bf16 v42, v50, v76, v42
    v_dot2_f32_bf16 v43, v51, v76, v43
    v_dot2_f32_bf16 v44, v52, v76, v44
    v_dot2_f32_bf16 v45, v53, v76, v45
    v_dot2_f32_bf16 v46, v54, v76, v46
    v_dot2_f32_bf16 v47, v55, v76, v47
    s_waitcnt vmcnt(12)
    v_perm_b32 v48, v188, v184, s72
    v_perm_b32 v49, v188, v184, s73
    v_perm_b32 v50, v189, v185, s72
    v_perm_b32 v51, v189, v185, s73
    v_perm_b32 v52, v190, v186, s72
    v_perm_b32 v53, v190, v186, s73
    v_perm_b32 v54, v191, v187, s72
    v_perm_b32 v55, v191, v187, s73
    v_dot2_f32_bf16 v32, v48, v63, v32
    v_dot2_f32_bf16 v33, v49, v63, v33
    v_dot2_f32_bf16 v34, v50, v63, v34
    v_dot2_f32_bf16 v35, v51, v63, v35
    v_dot2_f32_bf16 v36, v52, v63, v36
    v_dot2_f32_bf16 v37, v53, v63, v37
    v_dot2_f32_bf16 v38, v54, v63, v38
    v_dot2_f32_bf16 v39, v55, v63, v39
    v_dot2_f32_bf16 v40, v48, v77, v40
    v_dot2_f32_bf16 v41, v49, v77, v41
    v_dot2_f32_bf16 v42, v50, v77, v42
    v_dot2_f32_bf16 v43, v51, v77, v43
    v_dot2_f32_bf16 v44, v52, v77, v44
    v_dot2_f32_bf16 v45, v53, v77, v45
    v_dot2_f32_bf16 v46, v54, v77, v46
    v_dot2_f32_bf16 v47, v55, v77, v47
    s_waitcnt vmcnt(10)
    v_perm_b32 v48, v196, v192, s72
    v_perm_b32 v49, v196, v192, s73
    v_perm_b32 v50, v197, v193, s72
    v_perm_b32 v51, v197, v193, s73
    v_perm_b32 v52, v198, v194, s72
    v_perm_b32 v53, v198, v194, s73
    v_perm_b32 v54, v199, v195, s72
    v_perm_b32 v55, v199, v195, s73
    v_dot2_f32_bf16 v32, v48, v64, v32
    v_dot2_f32_bf16 v33, v49, v64, v33
    v_dot2_f32_bf16 v34, v50, v64, v34
    v_dot2_f32_bf16 v35, v51, v64, v35
    v_dot2_f32_bf16 v36, v52, v64, v36
    v_dot2_f32_bf16 v37, v53, v64, v37
    v_dot2_f32_bf16 v38, v54, v64, v38
    v_dot2_f32_bf16 v39, v55, v64, v39
    v_dot2_f32_bf16 v40, v48, v78, v40
    v_dot2_f32_bf16 v41, v49, v78, v41
    v_dot2_f32_bf16 v42, v50, v78, v42
    v_dot2_f32_bf16 v43, v51, v78, v43
    v_dot2_f32_bf16 v44, v52, v78, v44
    v_dot2_f32_bf16 v45, v53, v78, v45
    v_dot2_f32_bf16 v46, v54, v78, v46
    v_dot2_f32_bf16 v47, v55, v78, v47
    s_waitcnt vmcnt(8)
    v_perm_b32 v48, v204, v200, s72
    v_perm_b32 v49, v204, v200, s73
    v_perm_b32 v50, v205, v201, s72
    v_perm_b32 v51, v205, v201, s73
    v_perm_b32 v52, v206, v202, s72
    v_perm_b32 v53, v206, v202, s73
    v_perm_b32 v54, v207, v203, s72
    v_perm_b32 v55, v207, v203, s73
    v_dot2_f32_bf16 v32, v48, v65, v32
    v_dot2_f32_bf16 v33, v49, v65, v33
    v_dot2_f32_bf16 v34, v50, v65, v34
    v_dot2_f32_bf16 v35, v51, v65, v35
    v_dot2_f32_bf16 v36, v52, v65, v36
    v_dot2_f32_bf16 v37, v53, v65, v37
    v_dot2_f32_bf16 v38, v54, v65, v38
    v_dot2_f32_bf16 v39, v55, v65, v39
    v_dot2_f32_bf16 v40, v48, v79, v40
    v_dot2_f32_bf16 v41, v49, v79, v41
    v_dot2_f32_bf16 v42, v50, v79, v42
    v_dot2_f32_bf16 v43, v51, v79, v43
    v_dot2_f32_bf16 v44, v52, v79, v44
    v_dot2_f32_bf16 v45, v53, v79, v45
    v_dot2_f32_bf16 v46, v54, v79, v46
    v_dot2_f32_bf16 v47, v55, v79, v47
    s_waitcnt vmcnt(6)
    v_perm_b32 v48, v212, v208, s72
    v_perm_b32 v49, v212, v208, s73
    v_perm_b32 v50, v213, v209, s72
    v_perm_b32 v51, v213, v209, s73
    v_perm_b32 v52, v214, v210, s72
    v_perm_b32 v53, v214, v210, s73
    v_perm_b32 v54, v215, v211, s72
    v_perm_b32 v55, v215, v211, s73
    v_dot2_f32_bf16 v32, v48, v66, v32
    v_dot2_f32_bf16 v33, v49, v66, v33
    v_dot2_f32_bf16 v34, v50, v66, v34
    v_dot2_f32_bf16 v35, v51, v66, v35
    v_dot2_f32_bf16 v36, v52, v66, v36
    v_dot2_f32_bf16 v37, v53, v66, v37
    v_dot2_f32_bf16 v38, v54, v66, v38
    v_dot2_f32_bf16 v39, v55, v66, v39
    v_dot2_f32_bf16 v40, v48, v80, v40
    v_dot2_f32_bf16 v41, v49, v80, v41
    v_dot2_f32_bf16 v42, v50, v80, v42
    v_dot2_f32_bf16 v43, v51, v80, v43
    v_dot2_f32_bf16 v44, v52, v80, v44
    v_dot2_f32_bf16 v45, v53, v80, v45
    v_dot2_f32_bf16 v46, v54, v80, v46
    v_dot2_f32_bf16 v47, v55, v80, v47
    s_waitcnt vmcnt(4)
    v_perm_b32 v48, v220, v216, s72
    v_perm_b32 v49, v220, v216, s73
    v_perm_b32 v50, v221, v217, s72
    v_perm_b32 v51, v221, v217, s73
    v_perm_b32 v52, v222, v218, s72
    v_perm_b32 v53, v222, v218, s73
    v_perm_b32 v54, v223, v219, s72
    v_perm_b32 v55, v223, v219, s73
    v_dot2_f32_bf16 v32, v48, v67, v32
    v_dot2_f32_bf16 v33, v49, v67, v33
    v_dot2_f32_bf16 v34, v50, v67, v34
    v_dot2_f32_bf16 v35, v51, v67, v35
    v_dot2_f32_bf16 v36, v52, v67, v36
    v_dot2_f32_bf16 v37, v53, v67, v37
    v_dot2_f32_bf16 v38, v54, v67, v38
    v_dot2_f32_bf16 v39, v55, v67, v39
    v_dot2_f32_bf16 v40, v48, v81, v40
    v_dot2_f32_bf16 v41, v49, v81, v41
    v_dot2_f32_bf16 v42, v50, v81, v42
    v_dot2_f32_bf16 v43, v51, v81, v43
    v_dot2_f32_bf16 v44, v52, v81, v44
    v_dot2_f32_bf16 v45, v53, v81, v45
    v_dot2_f32_bf16 v46, v54, v81, v46
    v_dot2_f32_bf16 v47, v55, v81, v47
    s_waitcnt vmcnt(2)
    v_perm_b32 v48, v228, v224, s72
    v_perm_b32 v49, v228, v224, s73
    v_perm_b32 v50, v229, v225, s72
    v_perm_b32 v51, v229, v225, s73
    v_perm_b32 v52, v230, v226, s72
    v_perm_b32 v53, v230, v226, s73
    v_perm_b32 v54, v231, v227, s72
    v_perm_b32 v55, v231, v227, s73
    v_dot2_f32_bf16 v32, v48, v68, v32
    v_dot2_f32_bf16 v33, v49, v68, v33
    v_dot2_f32_bf16 v34, v50, v68, v34
    v_dot2_f32_bf16 v35, v51, v68, v35
    v_dot2_f32_bf16 v36, v52, v68, v36
    v_dot2_f32_bf16 v37, v53, v68, v37
    v_dot2_f32_bf16 v38, v54, v68, v38
    v_dot2_f32_bf16 v39, v55, v68, v39
    v_dot2_f32_bf16 v40, v48, v82, v40
    v_dot2_f32_bf16 v41, v49, v82, v41
    v_dot2_f32_bf16 v42, v50, v82, v42
    v_dot2_f32_bf16 v43, v51, v82, v43
    v_dot2_f32_bf16 v44, v52, v82, v44
    v_dot2_f32_bf16 v45, v53, v82, v45
    v_dot2_f32_bf16 v46, v54, v82, v46
    v_dot2_f32_bf16 v47, v55, v82, v47
    s_waitcnt vmcnt(0)
    s_barrier
    v_perm_b32 v48, v236, v232, s72
    v_perm_b32 v49, v236, v232, s73
    v_perm_b32 v50, v237, v233, s72
    v_perm_b32 v51, v237, v233, s73
    v_perm_b32 v52, v238, v234, s72
    v_perm_b32 v53, v238, v234, s73
    v_perm_b32 v54, v239, v235, s72
    v_perm_b32 v55, v239, v235, s73
    v_dot2_f32_bf16 v32, v48, v69, v32
    v_dot2_f32_bf16 v33, v49, v69, v33
    v_dot2_f32_bf16 v34, v50, v69, v34
    v_dot2_f32_bf16 v35, v51, v69, v35
    v_dot2_f32_bf16 v36, v52, v69, v36
    v_dot2_f32_bf16 v37, v53, v69, v37
    v_dot2_f32_bf16 v38, v54, v69, v38
    v_dot2_f32_bf16 v39, v55, v69, v39
    v_dot2_f32_bf16 v40, v48, v83, v40
    v_dot2_f32_bf16 v41, v49, v83, v41
    v_dot2_f32_bf16 v42, v50, v83, v42
    v_dot2_f32_bf16 v43, v51, v83, v43
    v_dot2_f32_bf16 v44, v52, v83, v44
    v_dot2_f32_bf16 v45, v53, v83, v45
    v_dot2_f32_bf16 v46, v54, v83, v46
    v_dot2_f32_bf16 v47, v55, v83, v47
    v_readfirstlane_b32 s4, v127
    s_add_u32 s4, s4, 1
    s_nop 1
    s_nop 1
    v_permlane32_swap_b32 v32, v40
    v_permlane32_swap_b32 v33, v41
    v_permlane32_swap_b32 v34, v42
    v_permlane32_swap_b32 v35, v43
    v_permlane32_swap_b32 v36, v44
    v_permlane32_swap_b32 v37, v45
    v_permlane32_swap_b32 v38, v46
    v_permlane32_swap_b32 v39, v47
    s_nop 1
    v_add_f32 v32, v32, v40
    v_add_f32 v33, v33, v41
    v_add_f32 v34, v34, v42
    v_add_f32 v35, v35, v43
    v_add_f32 v36, v36, v44
    v_add_f32 v37, v37, v45
    v_add_f32 v38, v38, v46
    v_add_f32 v39, v39, v47
    s_nop 1
    v_permlane16_swap_b32 v32, v36
    v_permlane16_swap_b32 v33, v37
    v_permlane16_swap_b32 v34, v38
    v_permlane16_swap_b32 v35, v39
    s_nop 1
    v_add_f32 v32, v32, v36
    v_add_f32 v33, v33, v37
    v_add_f32 v34, v34, v38
    v_add_f32 v35, v35, v39
    v_lshrrev_b32 v12, 1, v3
    v_lshlrev_b32 v12, 11, v12
    v_and_b32 v13, 1, v3
    v_lshl_add_u32 v12, v13, 5, v12
    v_lshl_add_u32 v12, v2, 6, v12
    s_lshl_b32 s98, s5, 1
    s_add_u32 s98, s98, s31
    s_lshl_b32 s99, s98, 5
    s_lshl_b32 s98, s98, 2
    s_add_u32 s98, s98, s8
    s_lshl_b32 s98, s98, 12
    s_lshl_b32 s100, s9, 10
    s_add_u32 s98, s98, s100
    s_add_u32 s98, s98, 65536
    v_mov_b32 v40, v32
    v_mov_b32 v41, s4
    v_mov_b32 v42, v33
    v_mov_b32 v43, s4
    v_mov_b32 v44, v34
    v_mov_b32 v45, s4
    v_mov_b32 v46, v35
    v_mov_b32 v47, s4
    buffer_store_dwordx4 v[40:43], v12, s[60:63], s98 offen sc1
    buffer_store_dwordx4 v[44:47], v12, s[60:63], s98 offen offset:16 sc1
    s_lshl_b32 s100, s8, 1
    s_add_u32 s100, s100, s9
    s_lshl_b32 s100, s100, 2
    s_add_u32 s99, s99, s100
    s_add_u32 s99, s99, 806912
    s_mov_b64 exec, 1
    buffer_store_dword v41, off, s[60:63], s99 sc1
    s_mov_b64 exec, -1
    s_mov_b32 s75, 0
    v_and_b32 v15, 15, v1
    v_lshlrev_b32 v15, 2, v15
    s_lshl_b32 s99, s5, 6
    s_add_u32 s99, s99, 806912
QH_5:
    buffer_load_dword v11, v15, s[60:63], s99 offen sc1
    s_waitcnt vmcnt(0)
    v_cmp_eq_u32 vcc, s4, v11
    s_cmp_eq_u64 vcc, exec
    s_cbranch_scc1 QHOK_6
    s_add_u32 s75, s75, 1
    s_sleep 1
    s_cmp_gt_u32 s75, 400000
    s_cbranch_scc0 QH_5
QHOK_6:
    s_mov_b32 s15, 1
    v_lshlrev_b32 v12, 4, v1
QG_7:
    s_lshl_b32 s99, s5, 6
    s_add_u32 s99, s99, 806912
    buffer_load_dword v11, v15, s[60:63], s99 offen sc1
    s_lshl_b32 s98, s5, 15
    s_add_u32 s98, s98, 65536
    s_lshl_b32 s99, s24, 11
    s_add_u32 s99, s99, s98
    buffer_load_dwordx4 v[32:35], v12, s[60:63], s99 offen offset:0 sc1
    buffer_load_dwordx4 v[36:39], v12, s[60:63], s99 offen offset:1024 sc1
    s_add_u32 s99, s99, 4096
    buffer_load_dwordx4 v[40:43], v12, s[60:63], s99 offen offset:0 sc1
    buffer_load_dwordx4 v[44:47], v12, s[60:63], s99 offen offset:1024 sc1
    s_add_u32 s99, s99, 4096
    buffer_load_dwordx4 v[48:51], v12, s[60:63], s99 offen offset:0 sc1
    buffer_load_dwordx4 v[52:55], v12, s[60:63], s99 offen offset:1024 sc1
    s_add_u32 s99, s99, 4096
    buffer_load_dwordx4 v[56:59], v12, s[60:63], s99 offen offset:0 sc1
    buffer_load_dwordx4 v[60:63], v12, s[60:63], s99 offen offset:1024 sc1
    s_add_u32 s99, s99, 4096
    s_add_u32 s99, s98, 16384
    buffer_load_dwordx4 v[64:67], v12, s[60:63], s99 offen offset:0 sc1
    buffer_load_dwordx4 v[68:71], v12, s[60:63], s99 offen offset:1024 sc1
    buffer_load_dwordx4 v[96:99], v12, s[60:63], s99 offen offset:2048 sc1
    buffer_load_dwordx4 v[100:103], v12, s[60:63], s99 offen offset:3072 sc1
    s_add_u32 s99, s99, 4096
    buffer_load_dwordx4 v[72:75], v12, s[60:63], s99 offen offset:0 sc1
    buffer_load_dwordx4 v[76:79], v12, s[60:63], s99 offen offset:1024 sc1
    buffer_load_dwordx4 v[104:107], v12, s[60:63], s99 offen offset:2048 sc1
    buffer_load_dwordx4 v[108:111], v12, s[60:63], s99 offen offset:3072 sc1
    s_add_u32 s99, s99, 4096
    buffer_load_dwordx4 v[80:83], v12, s[60:63], s99 offen offset:0 sc1
    buffer_load_dwordx4 v[84:87], v12, s[60:63], s99 offen offset:1024 sc1
    buffer_load_dwordx4 v[112:115], v12, s[60:63], s99 offen offset:2048 sc1
    buffer_load_dwordx4 v[116:119], v12, s[60:63], s99 offen offset:3072 sc1
    s_add_u32 s99, s99, 4096
    buffer_load_dwordx4 v[88:91], v12, s[60:63], s99 offen offset:0 sc1
    buffer_load_dwordx4 v[92:95], v12, s[60:63], s99 offen offset:1024 sc1
    buffer_load_dwordx4 v[120:123], v12, s[60:63], s99 offen offset:2048 sc1
    buffer_load_dwordx4 v[124:127], v12, s[60:63], s99 offen offset:3072 sc1
    s_add_u32 s99, s99, 4096
    s_cmp_eq_u32 s15, 0
    s_cbranch_scc1 QREL_9
    s_barrier
    s_mov_b32 s15, 0
QREL_9:
    s_waitcnt vmcnt(0)
    v_xor_b32 v13, s4, v11
    v_xor_b32 v14, s4, v33
    v_or_b32 v13, v13, v14
    v_xor_b32 v14, s4, v35
    v_or_b32 v13, v13, v14
    v_xor_b32 v14, s4, v37
    v_or_b32 v13, v13, v14
    v_xor_b32 v14, s4, v39
    v_or_b32 v13, v13, v14
    v_xor_b32 v14, s4, v41
    v_or_b32 v13, v13, v14
    v_xor_b32 v14, s4, v43
    v_or_b32 v13, v13, v14
    v_xor_b32 v14, s4, v45
    v_or_b32 v13, v13, v14
    v_xor_b32 v14, s4, v47
    v_or_b32 v13, v13, v14
    v_xor_b32 v14, s4, v49
    v_or_b32 v13, v13, v14
    v_xor_b32 v14, s4, v51
    v_or_b32 v13, v13, v14
    v_xor_b32 v14, s4, v53
    v_or_b32 v13, v13, v14
    v_xor_b32 v14, s4, v55
    v_or_b32 v13, v13, v14
    v_xor_b32 v14, s4, v57
    v_or_b32 v13, v13, v14
    v_xor_b32 v14, s4, v59
    v_or_b32 v13, v13, v14
    v_xor_b32 v14, s4, v61
    v_or_b32 v13, v13, v14
    v_xor_b32 v14, s4, v63
    v_or_b32 v13, v13, v14
    v_xor_b32 v14, s4, v65
    v_or_b32 v13, v13, v14
    v_xor_b32 v14, s4, v67
    v_or_b32 v13, v13, v14
    v_xor_b32 v14, s4, v69
    v_or_b32 v13, v13, v14
    v_xor_b32 v14, s4, v71
    v_or_b32 v13, v13, v14
    v_xor_b32 v14, s4, v73
    v_or_b32 v13, v13, v14
    v_xor_b32 v14, s4, v75
    v_or_b32 v13, v13, v14
    v_xor_b32 v14, s4, v77
    v_or_b32 v13, v13, v14
    v_xor_b32 v14, s4, v79
    v_or_b32 v13, v13, v14
    v_xor_b32 v14, s4, v81
    v_or_b32 v13, v13, v14
    v_xor_b32 v14, s4, v83
    v_or_b32 v13, v13, v14
    v_xor_b32 v14, s4, v85
    v_or_b32 v13, v13, v14
    v_xor_b32 v14, s4, v87
    v_or_b32 v13, v13, v14
    v_xor_b32 v14, s4, v89
    v_or_b32 v13, v13, v14
    v_xor_b32 v14, s4, v91
    v_or_b32 v13, v13, v14
    v_xor_b32 v14, s4, v93
    v_or_b32 v13, v13, v14
    v_xor_b32 v14, s4, v95
    v_or_b32 v13, v13, v14
    v_xor_b32 v14, s4, v97
    v_or_b32 v13, v13, v14
    v_xor_b32 v14, s4, v99
    v_or_b32 v13, v13, v14
    v_xor_b32 v14, s4, v101
    v_or_b32 v13, v13, v14
    v_xor_b32 v14, s4, v103
    v_or_b32 v13, v13, v14
    v_xor_b32 v14, s4, v105
    v_or_b32 v13, v13, v14
    v_xor_b32 v14, s4, v107
    v_or_b32 v13, v13, v14
    v_xor_b32 v14, s4, v109
    v_or_b32 v13, v13, v14
    v_xor_b32 v14, s4, v111
    v_or_b32 v13, v13, v14
    v_xor_b32 v14, s4, v113
    v_or_b32 v13, v13, v14
    v_xor_b32 v14, s4, v115
    v_or_b32 v13, v13, v14
    v_xor_b32 v14, s4, v117
    v_or_b32 v13, v13, v14
    v_xor_b32 v14, s4, v119
    v_or_b32 v13, v13, v14
    v_xor_b32 v14, s4, v121
    v_or_b32 v13, v13, v14
    v_xor_b32 v14, s4, v123
    v_or_b32 v13, v13, v14
    v_xor_b32 v14, s4, v125
    v_or_b32 v13, v13, v14
    v_xor_b32 v14, s4, v127
    v_or_b32 v13, v13, v14
    v_cmp_eq_u32 vcc, 0, v13
    s_cmp_eq_u64 vcc, exec
    s_cbranch_scc1 QGOK_8
    s_add_u32 s75, s75, 1
    s_cmp_gt_u32 s75, 400000
    s_cbranch_scc0 QG_7
QGOK_8:
    v_lshlrev_b32 v12, 2, v1
    v_add_u32 v13, 147456, v12
    s_lshl_b32 s99, s24, 9
    v_add_u32 v12, s99, v13
    v_add_f32 v32, v32, v40
    v_add_f32 v48, v48, v56
    v_add_f32 v32, v32, v48
    v_add_f32 v34, v34, v42
    v_add_f32 v50, v50, v58
    v_add_f32 v34, v34, v50
    v_cvt_pk_bf16_f32 v33, v32, v34
    ds_write_b32 v12, v33 offset:0
    v_add_f32 v36, v36, v44
    v_add_f32 v52, v52, v60
    v_add_f32 v36, v36, v52
    v_add_f32 v38, v38, v46
    v_add_f32 v54, v54, v62
    v_add_f32 v38, v38, v54
    v_cvt_pk_bf16_f32 v37, v36, v38
    ds_write_b32 v12, v37 offset:256
    v_add_f32 v64, v64, v72
    v_add_f32 v80, v80, v88
    v_add_f32 v64, v64, v80
    v_add_f32 v66, v66, v74
    v_add_f32 v82, v82, v90
    v_add_f32 v66, v66, v82
    v_cvt_pk_bf16_f32 v65, v64, v66
    ds_write_b32 v13, v65 offset:1024
    v_add_f32 v68, v68, v76
    v_add_f32 v84, v84, v92
    v_add_f32 v68, v68, v84
    v_add_f32 v70, v70, v78
    v_add_f32 v86, v86, v94
    v_add_f32 v70, v70, v86
    v_cvt_pk_bf16_f32 v69, v68, v70
    ds_write_b32 v13, v69 offset:1280
    v_add_f32 v96, v96, v104
    v_add_f32 v112, v112, v120
    v_add_f32 v96, v96, v112
    v_add_f32 v98, v98, v106
    v_add_f32 v114, v114, v122
    v_add_f32 v98, v98, v114
    v_cvt_pk_bf16_f32 v97, v96, v98
    ds_write_b32 v13, v97 offset:1536
    v_add_f32 v100, v100, v108
    v_add_f32 v116, v116, v124
    v_add_f32 v100, v100, v116
    v_add_f32 v102, v102, v110
    v_add_f32 v118, v118, v126
    v_add_f32 v102, v102, v118
    v_cvt_pk_bf16_f32 v101, v100, v102
    ds_write_b32 v13, v101 offset:1792
    s_waitcnt lgkmcnt(0)
QDONE_4:
    s_branch NOQ_2
NOQ_1:
    s_barrier
NOQ_2:
    s_mul_i32 s98, s6, 699056
    s_lshr_b32 s98, s98, 17
    s_add_u32 s99, s6, 1
    s_mul_i32 s99, s99, 699056
    s_lshr_b32 s99, s99, 17
    s_sub_u32 s33, s99, s98
    s_add_u32 s98, s98, s3
    s_sub_u32 s34, s98, 2
    s_cmp_lt_u32 s3, 2
    s_cselect_b32 s35, 0, 1
    s_cmp_ge_u32 s34, s99
    s_cselect_b32 s35, 0, s35
    s_cmp_eq_u32 s35, 0
    s_cbranch_scc1 NOUK_10
    v_lshlrev_b32 v12, 15, v3
    v_lshl_add_u32 v12, v2, 4, v12
    s_lshl_b32 s98, s34, 17
    s_lshl_b32 s99, s5, 9
    s_add_u32 s98, s98, s99
    buffer_load_dwordx4 v[128:131], v12, s[44:47], s98 offen offset:0 nt
    buffer_load_dwordx4 v[132:135], v12, s[44:47], s98 offen offset:256 nt
    s_add_u32 s98, s98, 8192
    buffer_load_dwordx4 v[136:139], v12, s[44:47], s98 offen offset:0 nt
    buffer_load_dwordx4 v[140:143], v12, s[44:47], s98 offen offset:256 nt
    s_add_u32 s98, s98, 8192
    buffer_load_dwordx4 v[144:147], v12, s[44:47], s98 offen offset:0 nt
    buffer_load_dwordx4 v[148:151], v12, s[44:47], s98 offen offset:256 nt
    s_add_u32 s98, s98, 8192
    buffer_load_dwordx4 v[152:155], v12, s[44:47], s98 offen offset:0 nt
    buffer_load_dwordx4 v[156:159], v12, s[44:47], s98 offen offset:256 nt
    s_add_u32 s98, s98, 8192
NOUK_10:
    s_cmp_eq_u32 s3, 0
    s_cbranch_scc1 W0_11
    s_barrier
W0_11:
    s_cmp_lg_u32 s35, 0
    s_cbranch_scc1 NOPRE_12
    buffer_load_dwordx4 v[192:195], v4, s[48:51], s17 offen offset:0 nt
    buffer_load_dwordx4 v[196:199], v4, s[48:51], s17 offen offset:256 nt
    buffer_load_dwordx4 v[200:203], v4, s[48:51], s17 offen offset:512 nt
    buffer_load_dwordx4 v[204:207], v4, s[48:51], s17 offen offset:768 nt
    buffer_load_dwordx4 v[208:211], v4, s[52:55], s17 offen offset:0 nt
    buffer_load_dwordx4 v[212:215], v4, s[52:55], s17 offen offset:512 nt
    buffer_load_dwordx4 v[216:219], v4, s[52:55], s17 offen offset:256 nt
    buffer_load_dwordx4 v[220:223], v4, s[52:55], s17 offen offset:768 nt
NOPRE_12:
    s_waitcnt lgkmcnt(0)
    s_barrier
    v_lshlrev_b32 v12, 4, v2
    s_lshl_b32 s98, s24, 9
    s_add_u32 s98, s98, 147456
    v_add_u32 v13, s98, v12
    ds_read_b128 v[16:19], v13
    ds_read_b128 v[20:23], v13 offset:256
    s_waitcnt vmcnt(8)
    s_cmp_eq_u32 s35, 0
    s_cbranch_scc1 UKW_13
    s_waitcnt vmcnt(0)
UKW_13:
    s_cmp_lt_u32 s3, 1
    s_cbranch_scc1 TAGOK_14
    v_readfirstlane_b32 s4, v127
    s_add_u32 s4, s4, 1
TAGOK_14:
    s_cmp_eq_u32 s35, 0
    s_cbranch_scc1 NOQABS_15
    v_add_u32 v13, 148480, v12
    ds_read_b128 v[64:67], v13 offset:0
    ds_read_b128 v[68:71], v13 offset:256
    ds_read_b128 v[72:75], v13 offset:512
    ds_read_b128 v[76:79], v13 offset:768
    s_waitcnt lgkmcnt(0)
    v_dot2_f32_bf16 v32, v128, v64, 0
    v_dot2_f32_bf16 v32, v129, v65, v32
    v_dot2_f32_bf16 v32, v130, v66, v32
    v_dot2_f32_bf16 v32, v131, v67, v32
    v_dot2_f32_bf16 v32, v132, v68, v32
    v_dot2_f32_bf16 v32, v133, v69, v32
    v_dot2_f32_bf16 v32, v134, v70, v32
    v_dot2_f32_bf16 v32, v135, v71, v32
    v_dot2_f32_bf16 v36, v128, v72, 0
    v_dot2_f32_bf16 v36, v129, v73, v36
    v_dot2_f32_bf16 v36, v130, v74, v36
    v_dot2_f32_bf16 v36, v131, v75, v36
    v_dot2_f32_bf16 v36, v132, v76, v36
    v_dot2_f32_bf16 v36, v133, v77, v36
    v_dot2_f32_bf16 v36, v134, v78, v36
    v_dot2_f32_bf16 v36, v135, v79, v36
    v_dot2_f32_bf16 v33, v136, v64, 0
    v_dot2_f32_bf16 v33, v137, v65, v33
    v_dot2_f32_bf16 v33, v138, v66, v33
    v_dot2_f32_bf16 v33, v139, v67, v33
    v_dot2_f32_bf16 v33, v140, v68, v33
    v_dot2_f32_bf16 v33, v141, v69, v33
    v_dot2_f32_bf16 v33, v142, v70, v33
    v_dot2_f32_bf16 v33, v143, v71, v33
    v_dot2_f32_bf16 v37, v136, v72, 0
    v_dot2_f32_bf16 v37, v137, v73, v37
    v_dot2_f32_bf16 v37, v138, v74, v37
    v_dot2_f32_bf16 v37, v139, v75, v37
    v_dot2_f32_bf16 v37, v140, v76, v37
    v_dot2_f32_bf16 v37, v141, v77, v37
    v_dot2_f32_bf16 v37, v142, v78, v37
    v_dot2_f32_bf16 v37, v143, v79, v37
    v_dot2_f32_bf16 v34, v144, v64, 0
    v_dot2_f32_bf16 v34, v145, v65, v34
    v_dot2_f32_bf16 v34, v146, v66, v34
    v_dot2_f32_bf16 v34, v147, v67, v34
    v_dot2_f32_bf16 v34, v148, v68, v34
    v_dot2_f32_bf16 v34, v149, v69, v34
    v_dot2_f32_bf16 v34, v150, v70, v34
    v_dot2_f32_bf16 v34, v151, v71, v34
    v_dot2_f32_bf16 v38, v144, v72, 0
    v_dot2_f32_bf16 v38, v145, v73, v38
    v_dot2_f32_bf16 v38, v146, v74, v38
    v_dot2_f32_bf16 v38, v147, v75, v38
    v_dot2_f32_bf16 v38, v148, v76, v38
    v_dot2_f32_bf16 v38, v149, v77, v38
    v_dot2_f32_bf16 v38, v150, v78, v38
    v_dot2_f32_bf16 v38, v151, v79, v38
    v_dot2_f32_bf16 v35, v152, v64, 0
    v_dot2_f32_bf16 v35, v153, v65, v35
    v_dot2_f32_bf16 v35, v154, v66, v35
    v_dot2_f32_bf16 v35, v155, v67, v35
    v_dot2_f32_bf16 v35, v156, v68, v35
    v_dot2_f32_bf16 v35, v157, v69, v35
    v_dot2_f32_bf16 v35, v158, v70, v35
    v_dot2_f32_bf16 v35, v159, v71, v35
    v_dot2_f32_bf16 v39, v152, v72, 0
    v_dot2_f32_bf16 v39, v153, v73, v39
    v_dot2_f32_bf16 v39, v154, v74, v39
    v_dot2_f32_bf16 v39, v155, v75, v39
    v_dot2_f32_bf16 v39, v156, v76, v39
    v_dot2_f32_bf16 v39, v157, v77, v39
    v_dot2_f32_bf16 v39, v158, v78, v39
    v_dot2_f32_bf16 v39, v159, v79, v39
    s_nop 2
    v_add_f32_dpp v32, v32, v32 row_ror:8 row_mask:0xf bank_mask:0xf
    v_add_f32_dpp v33, v33, v33 row_ror:8 row_mask:0xf bank_mask:0xf
    v_add_f32_dpp v34, v34, v34 row_ror:8 row_mask:0xf bank_mask:0xf
    v_add_f32_dpp v35, v35, v35 row_ror:8 row_mask:0xf bank_mask:0xf
    v_add_f32_dpp v36, v36, v36 row_ror:8 row_mask:0xf bank_mask:0xf
    v_add_f32_dpp v37, v37, v37 row_ror:8 row_mask:0xf bank_mask:0xf
    v_add_f32_dpp v38, v38, v38 row_ror:8 row_mask:0xf bank_mask:0xf
    v_add_f32_dpp v39, v39, v39 row_ror:8 row_mask:0xf bank_mask:0xf
    v_add_f32_dpp v32, v32, v32 row_ror:4 row_mask:0xf bank_mask:0xf
    v_add_f32_dpp v33, v33, v33 row_ror:4 row_mask:0xf bank_mask:0xf
    v_add_f32_dpp v34, v34, v34 row_ror:4 row_mask:0xf bank_mask:0xf
    v_add_f32_dpp v35, v35, v35 row_ror:4 row_mask:0xf bank_mask:0xf
    v_add_f32_dpp v36, v36, v36 row_ror:4 row_mask:0xf bank_mask:0xf
    v_add_f32_dpp v37, v37, v37 row_ror:4 row_mask:0xf bank_mask:0xf
    v_add_f32_dpp v38, v38, v38 row_ror:4 row_mask:0xf bank_mask:0xf
    v_add_f32_dpp v39, v39, v39 row_ror:4 row_mask:0xf bank_mask:0xf
    v_add_f32_dpp v32, v32, v32 row_ror:2 row_mask:0xf bank_mask:0xf
    v_add_f32_dpp v33, v33, v33 row_ror:2 row_mask:0xf bank_mask:0xf
    v_add_f32_dpp v34, v34, v34 row_ror:2 row_mask:0xf bank_mask:0xf
    v_add_f32_dpp v35, v35, v35 row_ror:2 row_mask:0xf bank_mask:0xf
    v_add_f32_dpp v36, v36, v36 row_ror:2 row_mask:0xf bank_mask:0xf
    v_add_f32_dpp v37, v37, v37 row_ror:2 row_mask:0xf bank_mask:0xf
    v_add_f32_dpp v38, v38, v38 row_ror:2 row_mask:0xf bank_mask:0xf
    v_add_f32_dpp v39, v39, v39 row_ror:2 row_mask:0xf bank_mask:0xf
    v_add_f32_dpp v32, v32, v32 row_ror:1 row_mask:0xf bank_mask:0xf
    v_add_f32_dpp v33, v33, v33 row_ror:1 row_mask:0xf bank_mask:0xf
    v_add_f32_dpp v34, v34, v34 row_ror:1 row_mask:0xf bank_mask:0xf
    v_add_f32_dpp v35, v35, v35 row_ror:1 row_mask:0xf bank_mask:0xf
    v_add_f32_dpp v36, v36, v36 row_ror:1 row_mask:0xf bank_mask:0xf
    v_add_f32_dpp v37, v37, v37 row_ror:1 row_mask:0xf bank_mask:0xf
    v_add_f32_dpp v38, v38, v38 row_ror:1 row_mask:0xf bank_mask:0xf
    v_add_f32_dpp v39, v39, v39 row_ror:1 row_mask:0xf bank_mask:0xf
    s_lshl_b64 s[78:79], s[76:77], 1
    v_cndmask_b32 v32, v32, v33, s[78:79]
    v_cndmask_b32 v36, v36, v37, s[78:79]
    s_lshl_b64 s[78:79], s[76:77], 2
    v_cndmask_b32 v32, v32, v34, s[78:79]
    v_cndmask_b32 v36, v36, v38, s[78:79]
    s_lshl_b64 s[78:79], s[76:77], 3
    v_cndmask_b32 v32, v32, v35, s[78:79]
    v_cndmask_b32 v36, v36, v39, s[78:79]
    v_lshl_add_u32 v14, v3, 2, v2
    s_lshl_b32 s99, s34, 4
    s_and_b32 s98, s99, 255
    v_add_u32 v14, s98, v14
    v_and_b32 v40, 7, v14
    v_lshlrev_b32 v40, 1, v40
    v_bfe_u32 v41, v14, 3, 1
    v_lshrrev_b32 v42, 6, v14
    v_lshl_add_u32 v41, v42, 1, v41
    v_lshl_add_u32 v40, v41, 11, v40
    v_bfe_u32 v41, v14, 4, 2
    v_lshl_add_u32 v14, v41, 8, v40
    s_lshr_b32 s98, s99, 8
    s_lshl_b32 s98, s98, 14
    s_lshl_b32 s99, s5, 4
    s_add_u32 s98, s98, s99
    v_cvt_pk_bf16_f32 v40, v32, v32
    v_lshlrev_b32 v41, 16, v40
    v_sub_f32 v41, v32, v41
    v_cvt_pk_bf16_f32 v41, v41, v41
    s_add_u32 s99, s98, 655360
    s_add_u32 s100, s98, 656384
    s_mov_b32 exec_lo, 0x000f000f
    s_mov_b32 exec_hi, 0x000f000f
    buffer_store_short v40, v14, s[60:63], s99 offen sc1
    buffer_store_short v41, v14, s[60:63], s100 offen sc1
    s_mov_b64 exec, -1
    v_cvt_pk_bf16_f32 v42, v36, v36
    v_lshlrev_b32 v43, 16, v42
    v_sub_f32 v43, v36, v43
    v_cvt_pk_bf16_f32 v43, v43, v43
    s_add_u32 s99, s98, 720896
    s_add_u32 s100, s98, 721920
    s_mov_b32 exec_lo, 0x000f000f
    s_mov_b32 exec_hi, 0x000f000f
    buffer_store_short v42, v14, s[60:63], s99 offen sc1
    buffer_store_short v43, v14, s[60:63], s100 offen sc1
    s_mov_b64 exec, -1
    v_mov_b32 v7, 1
    s_waitcnt vmcnt(0)
    s_mov_b64 exec, 1
    ds_add_rtn_u32 v6, v5, v7 offset:4
    s_waitcnt lgkmcnt(0)
    v_readfirstlane_b32 s98, v6
    s_add_u32 s98, s98, 1
    s_cmp_lg_u32 s98, s33
    s_cbranch_scc1 QAF_16
    s_lshl_b32 s98, s7, 2
    s_add_u32 s98, s98, 786432
    v_mov_b32 v13, s4
    buffer_store_dword v13, off, s[60:63], s98 sc1
QAF_16:
    s_mov_b64 exec, -1
    buffer_load_dwordx4 v[192:195], v4, s[48:51], s17 offen offset:0 nt
    buffer_load_dwordx4 v[196:199], v4, s[48:51], s17 offen offset:256 nt
    buffer_load_dwordx4 v[200:203], v4, s[48:51], s17 offen offset:512 nt
    buffer_load_dwordx4 v[204:207], v4, s[48:51], s17 offen offset:768 nt
    buffer_load_dwordx4 v[208:211], v4, s[52:55], s17 offen offset:0 nt
    buffer_load_dwordx4 v[212:215], v4, s[52:55], s17 offen offset:512 nt
    buffer_load_dwordx4 v[216:219], v4, s[52:55], s17 offen offset:256 nt
    buffer_load_dwordx4 v[220:223], v4, s[52:55], s17 offen offset:768 nt
NOQABS_15:
    s_cmp_ge_u32 s6, 4
    s_cbranch_scc1 NOWO_17
    s_lshl_b32 s9, s5, 8
    s_lshl_b32 s10, s6, 6
    s_add_u32 s9, s9, s10
    s_mul_i32 s8, s3, 8
    s_add_u32 s8, s8, s9
    s_mul_i32 s8, s8, 896
    v_lshlrev_b32 v12, 4, v1
    s_mov_b32 exec_hi, 0x00ffffff
    buffer_load_dwordx4 v[160:163], v12, s[68:71], s8 offen offset:0
    buffer_load_dwordx4 v[164:167], v12, s[68:71], s8 offen offset:896
    buffer_load_dwordx4 v[168:171], v12, s[68:71], s8 offen offset:1792
    buffer_load_dwordx4 v[172:175], v12, s[68:71], s8 offen offset:2688
    s_add_u32 s8, s8, 3584
    buffer_load_dwordx4 v[176:179], v12, s[68:71], s8 offen offset:0
    buffer_load_dwordx4 v[180:183], v12, s[68:71], s8 offen offset:896
    buffer_load_dwordx4 v[184:187], v12, s[68:71], s8 offen offset:1792
    buffer_load_dwordx4 v[188:191], v12, s[68:71], s8 offen offset:2688
    s_mov_b32 exec_hi, -1
NOWO_17:
    s_waitcnt lgkmcnt(0)
    s_branch L_A_MAIN
L_ROLE_B0:
    s_sub_u32 s99, s2, 192
    s_lshr_b32 s5, s99, 2
    s_and_b32 s6, s99, 3
    s_mov_b32 s7, s2
    s_lshr_b32 s24, s99, 5
    s_and_b32 s25, s99, 31
    s_and_b32 s26, s6, 1
    s_mov_b32 s8, s6
    s_mov_b32 s9, 1
    s_cmp_ge_u32 s3, 1
    s_cbranch_scc1 NOQB_18
    s_mul_i32 s12, s8, 224
    s_add_u32 s13, s12, 896
    s_mul_i32 s10, s8, 917504
    s_lshl_b32 s11, s5, 9
    s_add_u32 s10, s10, s11
    s_lshl_b32 s11, s9, 8
    s_add_u32 s10, s10, s11
    s_mov_b32 s14, 229376
    v_mul_lo_u32 v12, v3, s14
    v_lshl_add_u32 v12, v2, 4, v12
    v_mul_u32_u24 v13, 56, v3
    buffer_load_dwordx4 v[56:59], v13, s[36:39], s12 offen
    buffer_load_dwordx4 v[60:63], v13, s[36:39], s12 offen offset:16
    buffer_load_dwordx4 v[64:67], v13, s[36:39], s12 offen offset:32
    buffer_load_dwordx2 v[68:69], v13, s[36:39], s12 offen offset:48
    buffer_load_dwordx4 v[70:73], v13, s[36:39], s13 offen
    buffer_load_dwordx4 v[74:77], v13, s[36:39], s13 offen offset:16
    buffer_load_dwordx4 v[78:81], v13, s[36:39], s13 offen offset:32
    buffer_load_dwordx2 v[82:83], v13, s[36:39], s13 offen offset:48
    buffer_load_dwordx4 v[128:131], v12, s[40:43], s10 offen nt
    s_add_u32 s10, s10, 8192
    buffer_load_dwordx4 v[132:135], v12, s[40:43], s10 offen nt
    s_add_u32 s10, s10, 8192
    buffer_load_dwordx4 v[136:139], v12, s[40:43], s10 offen nt
    s_add_u32 s10, s10, 8192
    buffer_load_dwordx4 v[140:143], v12, s[40:43], s10 offen nt
    s_add_u32 s10, s10, 8192
    buffer_load_dwordx4 v[144:147], v12, s[40:43], s10 offen nt
    s_add_u32 s10, s10, 8192
    buffer_load_dwordx4 v[148:151], v12, s[40:43], s10 offen nt
    s_add_u32 s10, s10, 8192
    buffer_load_dwordx4 v[152:155], v12, s[40:43], s10 offen nt
    s_add_u32 s10, s10, 8192
    buffer_load_dwordx4 v[156:159], v12, s[40:43], s10 offen nt
    s_add_u32 s10, s10, 8192
    buffer_load_dwordx4 v[160:163], v12, s[40:43], s10 offen nt
    s_add_u32 s10, s10, 8192
    buffer_load_dwordx4 v[164:167], v12, s[40:43], s10 offen nt
    s_add_u32 s10, s10, 8192
    buffer_load_dwordx4 v[168:171], v12, s[40:43], s10 offen nt
    s_add_u32 s10, s10, 8192
    buffer_load_dwordx4 v[172:175], v12, s[40:43], s10 offen nt
    s_add_u32 s10, s10, 8192
    buffer_load_dwordx4 v[176:179], v12, s[40:43], s10 offen nt
    s_add_u32 s10, s10, 8192
    buffer_load_dwordx4 v[180:183], v12, s[40:43], s10 offen nt
    s_add_u32 s10, s10, 8192
    buffer_load_dwordx4 v[184:187], v12, s[40:43], s10 offen nt
    s_add_u32 s10, s10, 8192
    buffer_load_dwordx4 v[188:191], v12, s[40:43], s10 offen nt
    s_add_u32 s10, s10, 8192
    buffer_load_dwordx4 v[192:195], v12, s[40:43], s10 offen nt
    s_add_u32 s10, s10, 8192
    buffer_load_dwordx4 v[196:199], v12, s[40:43], s10 offen nt
    s_add_u32 s10, s10, 8192
    buffer_load_dwordx4 v[200:203], v12, s[40:43], s10 offen nt
    s_add_u32 s10, s10, 8192
    buffer_load_dwordx4 v[204:207], v12, s[40:43], s10 offen nt
    s_add_u32 s10, s10, 8192
    buffer_load_dwordx4 v[208:211], v12, s[40:43], s10 offen nt
    s_add_u32 s10, s10, 8192
    buffer_load_dwordx4 v[212:215], v12, s[40:43], s10 offen nt
    s_add_u32 s10, s10, 8192
    buffer_load_dwordx4 v[216:219], v12, s[40:43], s10 offen nt
    s_add_u32 s10, s10, 8192
    buffer_load_dwordx4 v[220:223], v12, s[40:43], s10 offen nt
    s_add_u32 s10, s10, 8192
    buffer_load_dwordx4 v[224:227], v12, s[40:43], s10 offen nt
    s_add_u32 s10, s10, 8192
    buffer_load_dwordx4 v[228:231], v12, s[40:43], s10 offen nt
    s_add_u32 s10, s10, 8192
    buffer_load_dwordx4 v[232:235], v12, s[40:43], s10 offen nt
    s_add_u32 s10, s10, 8192
    buffer_load_dwordx4 v[236:239], v12, s[40:43], s10 offen nt
    s_add_u32 s10, s10, 8192
    v_mov_b32 v32, 0
    v_mov_b32 v33, 0
    v_mov_b32 v34, 0
    v_mov_b32 v35, 0
    v_mov_b32 v36, 0
    v_mov_b32 v37, 0
    v_mov_b32 v38, 0
    v_mov_b32 v39, 0
    v_mov_b32 v40, 0
    v_mov_b32 v41, 0
    v_mov_b32 v42, 0
    v_mov_b32 v43, 0
    v_mov_b32 v44, 0
    v_mov_b32 v45, 0
    v_mov_b32 v46, 0
    v_mov_b32 v47, 0
    s_waitcnt vmcnt(26)
    v_perm_b32 v48, v132, v128, s72
    v_perm_b32 v49, v132, v128, s73
    v_perm_b32 v50, v133, v129, s72
    v_perm_b32 v51, v133, v129, s73
    v_perm_b32 v52, v134, v130, s72
    v_perm_b32 v53, v134, v130, s73
    v_perm_b32 v54, v135, v131, s72
    v_perm_b32 v55, v135, v131, s73
    v_dot2_f32_bf16 v32, v48, v56, v32
    v_dot2_f32_bf16 v33, v49, v56, v33
    v_dot2_f32_bf16 v34, v50, v56, v34
    v_dot2_f32_bf16 v35, v51, v56, v35
    v_dot2_f32_bf16 v36, v52, v56, v36
    v_dot2_f32_bf16 v37, v53, v56, v37
    v_dot2_f32_bf16 v38, v54, v56, v38
    v_dot2_f32_bf16 v39, v55, v56, v39
    v_dot2_f32_bf16 v40, v48, v70, v40
    v_dot2_f32_bf16 v41, v49, v70, v41
    v_dot2_f32_bf16 v42, v50, v70, v42
    v_dot2_f32_bf16 v43, v51, v70, v43
    v_dot2_f32_bf16 v44, v52, v70, v44
    v_dot2_f32_bf16 v45, v53, v70, v45
    v_dot2_f32_bf16 v46, v54, v70, v46
    v_dot2_f32_bf16 v47, v55, v70, v47
    s_waitcnt vmcnt(24)
    v_perm_b32 v48, v140, v136, s72
    v_perm_b32 v49, v140, v136, s73
    v_perm_b32 v50, v141, v137, s72
    v_perm_b32 v51, v141, v137, s73
    v_perm_b32 v52, v142, v138, s72
    v_perm_b32 v53, v142, v138, s73
    v_perm_b32 v54, v143, v139, s72
    v_perm_b32 v55, v143, v139, s73
    v_dot2_f32_bf16 v32, v48, v57, v32
    v_dot2_f32_bf16 v33, v49, v57, v33
    v_dot2_f32_bf16 v34, v50, v57, v34
    v_dot2_f32_bf16 v35, v51, v57, v35
    v_dot2_f32_bf16 v36, v52, v57, v36
    v_dot2_f32_bf16 v37, v53, v57, v37
    v_dot2_f32_bf16 v38, v54, v57, v38
    v_dot2_f32_bf16 v39, v55, v57, v39
    v_dot2_f32_bf16 v40, v48, v71, v40
    v_dot2_f32_bf16 v41, v49, v71, v41
    v_dot2_f32_bf16 v42, v50, v71, v42
    v_dot2_f32_bf16 v43, v51, v71, v43
    v_dot2_f32_bf16 v44, v52, v71, v44
    v_dot2_f32_bf16 v45, v53, v71, v45
    v_dot2_f32_bf16 v46, v54, v71, v46
    v_dot2_f32_bf16 v47, v55, v71, v47
    s_waitcnt vmcnt(22)
    v_perm_b32 v48, v148, v144, s72
    v_perm_b32 v49, v148, v144, s73
    v_perm_b32 v50, v149, v145, s72
    v_perm_b32 v51, v149, v145, s73
    v_perm_b32 v52, v150, v146, s72
    v_perm_b32 v53, v150, v146, s73
    v_perm_b32 v54, v151, v147, s72
    v_perm_b32 v55, v151, v147, s73
    v_dot2_f32_bf16 v32, v48, v58, v32
    v_dot2_f32_bf16 v33, v49, v58, v33
    v_dot2_f32_bf16 v34, v50, v58, v34
    v_dot2_f32_bf16 v35, v51, v58, v35
    v_dot2_f32_bf16 v36, v52, v58, v36
    v_dot2_f32_bf16 v37, v53, v58, v37
    v_dot2_f32_bf16 v38, v54, v58, v38
    v_dot2_f32_bf16 v39, v55, v58, v39
    v_dot2_f32_bf16 v40, v48, v72, v40
    v_dot2_f32_bf16 v41, v49, v72, v41
    v_dot2_f32_bf16 v42, v50, v72, v42
    v_dot2_f32_bf16 v43, v51, v72, v43
    v_dot2_f32_bf16 v44, v52, v72, v44
    v_dot2_f32_bf16 v45, v53, v72, v45
    v_dot2_f32_bf16 v46, v54, v72, v46
    v_dot2_f32_bf16 v47, v55, v72, v47
    s_waitcnt vmcnt(20)
    v_perm_b32 v48, v156, v152, s72
    v_perm_b32 v49, v156, v152, s73
    v_perm_b32 v50, v157, v153, s72
    v_perm_b32 v51, v157, v153, s73
    v_perm_b32 v52, v158, v154, s72
    v_perm_b32 v53, v158, v154, s73
    v_perm_b32 v54, v159, v155, s72
    v_perm_b32 v55, v159, v155, s73
    v_dot2_f32_bf16 v32, v48, v59, v32
    v_dot2_f32_bf16 v33, v49, v59, v33
    v_dot2_f32_bf16 v34, v50, v59, v34
    v_dot2_f32_bf16 v35, v51, v59, v35
    v_dot2_f32_bf16 v36, v52, v59, v36
    v_dot2_f32_bf16 v37, v53, v59, v37
    v_dot2_f32_bf16 v38, v54, v59, v38
    v_dot2_f32_bf16 v39, v55, v59, v39
    v_dot2_f32_bf16 v40, v48, v73, v40
    v_dot2_f32_bf16 v41, v49, v73, v41
    v_dot2_f32_bf16 v42, v50, v73, v42
    v_dot2_f32_bf16 v43, v51, v73, v43
    v_dot2_f32_bf16 v44, v52, v73, v44
    v_dot2_f32_bf16 v45, v53, v73, v45
    v_dot2_f32_bf16 v46, v54, v73, v46
    v_dot2_f32_bf16 v47, v55, v73, v47
    s_waitcnt vmcnt(18)
    v_perm_b32 v48, v164, v160, s72
    v_perm_b32 v49, v164, v160, s73
    v_perm_b32 v50, v165, v161, s72
    v_perm_b32 v51, v165, v161, s73
    v_perm_b32 v52, v166, v162, s72
    v_perm_b32 v53, v166, v162, s73
    v_perm_b32 v54, v167, v163, s72
    v_perm_b32 v55, v167, v163, s73
    v_dot2_f32_bf16 v32, v48, v60, v32
    v_dot2_f32_bf16 v33, v49, v60, v33
    v_dot2_f32_bf16 v34, v50, v60, v34
    v_dot2_f32_bf16 v35, v51, v60, v35
    v_dot2_f32_bf16 v36, v52, v60, v36
    v_dot2_f32_bf16 v37, v53, v60, v37
    v_dot2_f32_bf16 v38, v54, v60, v38
    v_dot2_f32_bf16 v39, v55, v60, v39
    v_dot2_f32_bf16 v40, v48, v74, v40
    v_dot2_f32_bf16 v41, v49, v74, v41
    v_dot2_f32_bf16 v42, v50, v74, v42
    v_dot2_f32_bf16 v43, v51, v74, v43
    v_dot2_f32_bf16 v44, v52, v74, v44
    v_dot2_f32_bf16 v45, v53, v74, v45
    v_dot2_f32_bf16 v46, v54, v74, v46
    v_dot2_f32_bf16 v47, v55, v74, v47
    s_waitcnt vmcnt(16)
    v_perm_b32 v48, v172, v168, s72
    v_perm_b32 v49, v172, v168, s73
    v_perm_b32 v50, v173, v169, s72
    v_perm_b32 v51, v173, v169, s73
    v_perm_b32 v52, v174, v170, s72
    v_perm_b32 v53, v174, v170, s73
    v_perm_b32 v54, v175, v171, s72
    v_perm_b32 v55, v175, v171, s73
    v_dot2_f32_bf16 v32, v48, v61, v32
    v_dot2_f32_bf16 v33, v49, v61, v33
    v_dot2_f32_bf16 v34, v50, v61, v34
    v_dot2_f32_bf16 v35, v51, v61, v35
    v_dot2_f32_bf16 v36, v52, v61, v36
    v_dot2_f32_bf16 v37, v53, v61, v37
    v_dot2_f32_bf16 v38, v54, v61, v38
    v_dot2_f32_bf16 v39, v55, v61, v39
    v_dot2_f32_bf16 v40, v48, v75, v40
    v_dot2_f32_bf16 v41, v49, v75, v41
    v_dot2_f32_bf16 v42, v50, v75, v42
    v_dot2_f32_bf16 v43, v51, v75, v43
    v_dot2_f32_bf16 v44, v52, v75, v44
    v_dot2_f32_bf16 v45, v53, v75, v45
    v_dot2_f32_bf16 v46, v54, v75, v46
    v_dot2_f32_bf16 v47, v55, v75, v47
    s_waitcnt vmcnt(14)
    v_perm_b32 v48, v180, v176, s72
    v_perm_b32 v49, v180, v176, s73
    v_perm_b32 v50, v181, v177, s72
    v_perm_b32 v51, v181, v177, s73
    v_perm_b32 v52, v182, v178, s72
    v_perm_b32 v53, v182, v178, s73
    v_perm_b32 v54, v183, v179, s72
    v_perm_b32 v55, v183, v179, s73
    v_dot2_f32_bf16 v32, v48, v62, v32
    v_dot2_f32_bf16 v33, v49, v62, v33
    v_dot2_f32_bf16 v34, v50, v62, v34
    v_dot2_f32_bf16 v35, v51, v62, v35
    v_dot2_f32_bf16 v36, v52, v62, v36
    v_dot2_f32_bf16 v37, v53, v62, v37
    v_dot2_f32_bf16 v38, v54, v62, v38
    v_dot2_f32_bf16 v39, v55, v62, v39
    v_dot2_f32_bf16 v40, v48, v76, v40
    v_dot2_f32_bf16 v41, v49, v76, v41
    v_dot2_f32_bf16 v42, v50, v76, v42
    v_dot2_f32_bf16 v43, v51, v76, v43
    v_dot2_f32_bf16 v44, v52, v76, v44
    v_dot2_f32_bf16 v45, v53, v76, v45
    v_dot2_f32_bf16 v46, v54, v76, v46
    v_dot2_f32_bf16 v47, v55, v76, v47
    s_waitcnt vmcnt(12)
    v_perm_b32 v48, v188, v184, s72
    v_perm_b32 v49, v188, v184, s73
    v_perm_b32 v50, v189, v185, s72
    v_perm_b32 v51, v189, v185, s73
    v_perm_b32 v52, v190, v186, s72
    v_perm_b32 v53, v190, v186, s73
    v_perm_b32 v54, v191, v187, s72
    v_perm_b32 v55, v191, v187, s73
    v_dot2_f32_bf16 v32, v48, v63, v32
    v_dot2_f32_bf16 v33, v49, v63, v33
    v_dot2_f32_bf16 v34, v50, v63, v34
    v_dot2_f32_bf16 v35, v51, v63, v35
    v_dot2_f32_bf16 v36, v52, v63, v36
    v_dot2_f32_bf16 v37, v53, v63, v37
    v_dot2_f32_bf16 v38, v54, v63, v38
    v_dot2_f32_bf16 v39, v55, v63, v39
    v_dot2_f32_bf16 v40, v48, v77, v40
    v_dot2_f32_bf16 v41, v49, v77, v41
    v_dot2_f32_bf16 v42, v50, v77, v42
    v_dot2_f32_bf16 v43, v51, v77, v43
    v_dot2_f32_bf16 v44, v52, v77, v44
    v_dot2_f32_bf16 v45, v53, v77, v45
    v_dot2_f32_bf16 v46, v54, v77, v46
    v_dot2_f32_bf16 v47, v55, v77, v47
    s_waitcnt vmcnt(10)
    v_perm_b32 v48, v196, v192, s72
    v_perm_b32 v49, v196, v192, s73
    v_perm_b32 v50, v197, v193, s72
    v_perm_b32 v51, v197, v193, s73
    v_perm_b32 v52, v198, v194, s72
    v_perm_b32 v53, v198, v194, s73
    v_perm_b32 v54, v199, v195, s72
    v_perm_b32 v55, v199, v195, s73
    v_dot2_f32_bf16 v32, v48, v64, v32
    v_dot2_f32_bf16 v33, v49, v64, v33
    v_dot2_f32_bf16 v34, v50, v64, v34
    v_dot2_f32_bf16 v35, v51, v64, v35
    v_dot2_f32_bf16 v36, v52, v64, v36
    v_dot2_f32_bf16 v37, v53, v64, v37
    v_dot2_f32_bf16 v38, v54, v64, v38
    v_dot2_f32_bf16 v39, v55, v64, v39
    v_dot2_f32_bf16 v40, v48, v78, v40
    v_dot2_f32_bf16 v41, v49, v78, v41
    v_dot2_f32_bf16 v42, v50, v78, v42
    v_dot2_f32_bf16 v43, v51, v78, v43
    v_dot2_f32_bf16 v44, v52, v78, v44
    v_dot2_f32_bf16 v45, v53, v78, v45
    v_dot2_f32_bf16 v46, v54, v78, v46
    v_dot2_f32_bf16 v47, v55, v78, v47
    s_waitcnt vmcnt(8)
    v_perm_b32 v48, v204, v200, s72
    v_perm_b32 v49, v204, v200, s73
    v_perm_b32 v50, v205, v201, s72
    v_perm_b32 v51, v205, v201, s73
    v_perm_b32 v52, v206, v202, s72
    v_perm_b32 v53, v206, v202, s73
    v_perm_b32 v54, v207, v203, s72
    v_perm_b32 v55, v207, v203, s73
    v_dot2_f32_bf16 v32, v48, v65, v32
    v_dot2_f32_bf16 v33, v49, v65, v33
    v_dot2_f32_bf16 v34, v50, v65, v34
    v_dot2_f32_bf16 v35, v51, v65, v35
    v_dot2_f32_bf16 v36, v52, v65, v36
    v_dot2_f32_bf16 v37, v53, v65, v37
    v_dot2_f32_bf16 v38, v54, v65, v38
    v_dot2_f32_bf16 v39, v55, v65, v39
    v_dot2_f32_bf16 v40, v48, v79, v40
    v_dot2_f32_bf16 v41, v49, v79, v41
    v_dot2_f32_bf16 v42, v50, v79, v42
    v_dot2_f32_bf16 v43, v51, v79, v43
    v_dot2_f32_bf16 v44, v52, v79, v44
    v_dot2_f32_bf16 v45, v53, v79, v45
    v_dot2_f32_bf16 v46, v54, v79, v46
    v_dot2_f32_bf16 v47, v55, v79, v47
    s_waitcnt vmcnt(6)
    v_perm_b32 v48, v212, v208, s72
    v_perm_b32 v49, v212, v208, s73
    v_perm_b32 v50, v213, v209, s72
    v_perm_b32 v51, v213, v209, s73
    v_perm_b32 v52, v214, v210, s72
    v_perm_b32 v53, v214, v210, s73
    v_perm_b32 v54, v215, v211, s72
    v_perm_b32 v55, v215, v211, s73
    v_dot2_f32_bf16 v32, v48, v66, v32
    v_dot2_f32_bf16 v33, v49, v66, v33
    v_dot2_f32_bf16 v34, v50, v66, v34
    v_dot2_f32_bf16 v35, v51, v66, v35
    v_dot2_f32_bf16 v36, v52, v66, v36
    v_dot2_f32_bf16 v37, v53, v66, v37
    v_dot2_f32_bf16 v38, v54, v66, v38
    v_dot2_f32_bf16 v39, v55, v66, v39
    v_dot2_f32_bf16 v40, v48, v80, v40
    v_dot2_f32_bf16 v41, v49, v80, v41
    v_dot2_f32_bf16 v42, v50, v80, v42
    v_dot2_f32_bf16 v43, v51, v80, v43
    v_dot2_f32_bf16 v44, v52, v80, v44
    v_dot2_f32_bf16 v45, v53, v80, v45
    v_dot2_f32_bf16 v46, v54, v80, v46
    v_dot2_f32_bf16 v47, v55, v80, v47
    s_waitcnt vmcnt(4)
    v_perm_b32 v48, v220, v216, s72
    v_perm_b32 v49, v220, v216, s73
    v_perm_b32 v50, v221, v217, s72
    v_perm_b32 v51, v221, v217, s73
    v_perm_b32 v52, v222, v218, s72
    v_perm_b32 v53, v222, v218, s73
    v_perm_b32 v54, v223, v219, s72
    v_perm_b32 v55, v223, v219, s73
    v_dot2_f32_bf16 v32, v48, v67, v32
    v_dot2_f32_bf16 v33, v49, v67, v33
    v_dot2_f32_bf16 v34, v50, v67, v34
    v_dot2_f32_bf16 v35, v51, v67, v35
    v_dot2_f32_bf16 v36, v52, v67, v36
    v_dot2_f32_bf16 v37, v53, v67, v37
    v_dot2_f32_bf16 v38, v54, v67, v38
    v_dot2_f32_bf16 v39, v55, v67, v39
    v_dot2_f32_bf16 v40, v48, v81, v40
    v_dot2_f32_bf16 v41, v49, v81, v41
    v_dot2_f32_bf16 v42, v50, v81, v42
    v_dot2_f32_bf16 v43, v51, v81, v43
    v_dot2_f32_bf16 v44, v52, v81, v44
    v_dot2_f32_bf16 v45, v53, v81, v45
    v_dot2_f32_bf16 v46, v54, v81, v46
    v_dot2_f32_bf16 v47, v55, v81, v47
    s_waitcnt vmcnt(2)
    v_perm_b32 v48, v228, v224, s72
    v_perm_b32 v49, v228, v224, s73
    v_perm_b32 v50, v229, v225, s72
    v_perm_b32 v51, v229, v225, s73
    v_perm_b32 v52, v230, v226, s72
    v_perm_b32 v53, v230, v226, s73
    v_perm_b32 v54, v231, v227, s72
    v_perm_b32 v55, v231, v227, s73
    v_dot2_f32_bf16 v32, v48, v68, v32
    v_dot2_f32_bf16 v33, v49, v68, v33
    v_dot2_f32_bf16 v34, v50, v68, v34
    v_dot2_f32_bf16 v35, v51, v68, v35
    v_dot2_f32_bf16 v36, v52, v68, v36
    v_dot2_f32_bf16 v37, v53, v68, v37
    v_dot2_f32_bf16 v38, v54, v68, v38
    v_dot2_f32_bf16 v39, v55, v68, v39
    v_dot2_f32_bf16 v40, v48, v82, v40
    v_dot2_f32_bf16 v41, v49, v82, v41
    v_dot2_f32_bf16 v42, v50, v82, v42
    v_dot2_f32_bf16 v43, v51, v82, v43
    v_dot2_f32_bf16 v44, v52, v82, v44
    v_dot2_f32_bf16 v45, v53, v82, v45
    v_dot2_f32_bf16 v46, v54, v82, v46
    v_dot2_f32_bf16 v47, v55, v82, v47
    s_waitcnt vmcnt(0)
    s_barrier
    v_perm_b32 v48, v236, v232, s72
    v_perm_b32 v49, v236, v232, s73
    v_perm_b32 v50, v237, v233, s72
    v_perm_b32 v51, v237, v233, s73
    v_perm_b32 v52, v238, v234, s72
    v_perm_b32 v53, v238, v234, s73
    v_perm_b32 v54, v239, v235, s72
    v_perm_b32 v55, v239, v235, s73
    v_dot2_f32_bf16 v32, v48, v69, v32
    v_dot2_f32_bf16 v33, v49, v69, v33
    v_dot2_f32_bf16 v34, v50, v69, v34
    v_dot2_f32_bf16 v35, v51, v69, v35
    v_dot2_f32_bf16 v36, v52, v69, v36
    v_dot2_f32_bf16 v37, v53, v69, v37
    v_dot2_f32_bf16 v38, v54, v69, v38
    v_dot2_f32_bf16 v39, v55, v69, v39
    v_dot2_f32_bf16 v40, v48, v83, v40
    v_dot2_f32_bf16 v41, v49, v83, v41
    v_dot2_f32_bf16 v42, v50, v83, v42
    v_dot2_f32_bf16 v43, v51, v83, v43
    v_dot2_f32_bf16 v44, v52, v83, v44
    v_dot2_f32_bf16 v45, v53, v83, v45
    v_dot2_f32_bf16 v46, v54, v83, v46
    v_dot2_f32_bf16 v47, v55, v83, v47
    v_readfirstlane_b32 s4, v127
    s_add_u32 s4, s4, 1
    s_nop 1
    s_nop 1
    v_permlane32_swap_b32 v32, v40
    v_permlane32_swap_b32 v33, v41
    v_permlane32_swap_b32 v34, v42
    v_permlane32_swap_b32 v35, v43
    v_permlane32_swap_b32 v36, v44
    v_permlane32_swap_b32 v37, v45
    v_permlane32_swap_b32 v38, v46
    v_permlane32_swap_b32 v39, v47
    s_nop 1
    v_add_f32 v32, v32, v40
    v_add_f32 v33, v33, v41
    v_add_f32 v34, v34, v42
    v_add_f32 v35, v35, v43
    v_add_f32 v36, v36, v44
    v_add_f32 v37, v37, v45
    v_add_f32 v38, v38, v46
    v_add_f32 v39, v39, v47
    s_nop 1
    v_permlane16_swap_b32 v32, v36
    v_permlane16_swap_b32 v33, v37
    v_permlane16_swap_b32 v34, v38
    v_permlane16_swap_b32 v35, v39
    s_nop 1
    v_add_f32 v32, v32, v36
    v_add_f32 v33, v33, v37
    v_add_f32 v34, v34, v38
    v_add_f32 v35, v35, v39
    v_lshrrev_b32 v12, 1, v3
    v_lshlrev_b32 v12, 11, v12
    v_and_b32 v13, 1, v3
    v_lshl_add_u32 v12, v13, 5, v12
    v_lshl_add_u32 v12, v2, 6, v12
    s_lshl_b32 s98, s5, 1
    s_add_u32 s98, s98, s31
    s_lshl_b32 s99, s98, 5
    s_lshl_b32 s98, s98, 2
    s_add_u32 s98, s98, s8
    s_lshl_b32 s98, s98, 12
    s_lshl_b32 s100, s9, 10
    s_add_u32 s98, s98, s100
    s_add_u32 s98, s98, 65536
    v_mov_b32 v40, v32
    v_mov_b32 v41, s4
    v_mov_b32 v42, v33
    v_mov_b32 v43, s4
    v_mov_b32 v44, v34
    v_mov_b32 v45, s4
    v_mov_b32 v46, v35
    v_mov_b32 v47, s4
    buffer_store_dwordx4 v[40:43], v12, s[60:63], s98 offen sc1
    buffer_store_dwordx4 v[44:47], v12, s[60:63], s98 offen offset:16 sc1
    s_lshl_b32 s100, s8, 1
    s_add_u32 s100, s100, s9
    s_lshl_b32 s100, s100, 2
    s_add_u32 s99, s99, s100
    s_add_u32 s99, s99, 806912
    s_mov_b64 exec, 1
    buffer_store_dword v41, off, s[60:63], s99 sc1
    s_mov_b64 exec, -1
QDONE_20:
    s_branch NOQB_19
NOQB_18:
    s_barrier
NOQB_19:
    s_branch L_ROLE_B
L_A_MAIN:
    v_mov_b32 v32, 0
    v_mov_b32 v33, 0
    v_mov_b32 v34, 0
    v_mov_b32 v35, 0
    v_mov_b32 v36, 0
    v_mov_b32 v37, 0
    v_mov_b32 v38, 0
    v_mov_b32 v39, 0
    v_mov_b32 v40, 0
    v_mov_b32 v41, 0
    v_mov_b32 v42, 0
    v_mov_b32 v43, 0
    v_mov_b32 v44, 0
    v_mov_b32 v45, 0
    v_mov_b32 v46, 0
    v_mov_b32 v47, 0
    v_mov_b32 v8, 0xff800000
    v_mov_b32 v9, 0
    v_mov_b32 v7, 1
    s_mov_b32 s21, 1
    s_mov_b32 s22, 1
    s_mov_b32 s27, 0
    s_mov_b32 s29, 0x3db8aa3b
A_LOOP:
    s_mov_b64 exec, 1
    s_cmp_lg_u32 s27, 0
    s_cbranch_scc1 GR_21
    ds_add_rtn_u32 v6, v5, v7
    s_branch GR_22
GR_21:
    v_mov_b32 v6, 1
    buffer_atomic_add v6, off, s[60:63], s26 sc0 sc1
GR_22:
    s_mov_b64 exec, -1
    s_waitcnt vmcnt(4)
    v_dot2_f32_bf16 v108, v192, v16, 0
    v_dot2_f32_bf16 v112, v196, v20, 0
    v_dot2_f32_bf16 v108, v193, v17, v108
    v_dot2_f32_bf16 v112, v197, v21, v112
    v_dot2_f32_bf16 v108, v194, v18, v108
    v_dot2_f32_bf16 v112, v198, v22, v112
    v_dot2_f32_bf16 v108, v195, v19, v108
    v_dot2_f32_bf16 v112, v199, v23, v112
    s_cmp_eq_u32 s21, 0
    s_cbranch_scc1 I_24
    s_sub_u32 s21, s21, 1
    s_branch I_23
I_24:
    buffer_load_dwordx4 v[216:219], v4, s[52:55], s17 offen offset:256 nt
    buffer_load_dwordx4 v[220:223], v4, s[52:55], s17 offen offset:768 nt
I_23:
    s_waitcnt vmcnt(4)
    v_dot2_f32_bf16 v109, v200, v16, 0
    v_dot2_f32_bf16 v113, v204, v20, 0
    v_dot2_f32_bf16 v109, v201, v17, v109
    v_dot2_f32_bf16 v113, v205, v21, v113
    v_dot2_f32_bf16 v109, v202, v18, v109
    v_dot2_f32_bf16 v113, v206, v22, v113
    v_dot2_f32_bf16 v109, v203, v19, v109
    v_dot2_f32_bf16 v113, v207, v23, v113
    s_waitcnt vmcnt(2) lgkmcnt(0)
    v_readfirstlane_b32 s23, v6
    s_cmp_lg_u32 s27, 0
    s_cbranch_scc1 RG_25
    s_add_u32 s98, s23, 8
    s_cmp_ge_u32 s98, s19
    s_cselect_b32 s27, 1, 0
    s_cmp_lt_u32 s23, s19
    s_cbranch_scc1 RF_26
    s_mov_b64 exec, 1
    v_mov_b32 v6, 1
    buffer_atomic_add v6, off, s[60:63], s26 sc0 sc1
    s_mov_b64 exec, -1
    s_waitcnt vmcnt(0)
    v_readfirstlane_b32 s23, v6
RG_25:
    s_min_u32 s23, s23, 4096
    s_add_u32 s23, s23, 384
    s_cmp_lt_u32 s23, 512
    s_cselect_b32 s22, 1, 0
RF_26:
    s_lshl_b32 s18, s23, 12
    s_add_u32 s18, s18, s20
    s_cmp_eq_u32 s21, 0
    s_cbranch_scc1 I_29
    s_sub_u32 s21, s21, 1
    s_branch I_28
I_29:
    s_cmp_eq_u32 s22, 0
    s_cbranch_scc1 I_28
    buffer_load_dwordx4 v[224:227], v4, s[48:51], s18 offen offset:0 nt
    buffer_load_dwordx4 v[228:231], v4, s[48:51], s18 offen offset:256 nt
I_28:
    s_nop 2
    v_add_f32 v108, v108, v112
    v_add_f32 v109, v109, v113
    s_nop 1
    v_add_f32_dpp v108, v108, v108 row_ror:8 row_mask:0xf bank_mask:0xf
    v_add_f32_dpp v109, v109, v109 row_ror:8 row_mask:0xf bank_mask:0xf
    s_nop 1
    v_add_f32_dpp v108, v108, v108 row_ror:4 row_mask:0xf bank_mask:0xf
    v_add_f32_dpp v109, v109, v109 row_ror:4 row_mask:0xf bank_mask:0xf
    s_nop 1
    v_add_f32_dpp v108, v108, v108 row_ror:2 row_mask:0xf bank_mask:0xf
    v_add_f32_dpp v109, v109, v109 row_ror:2 row_mask:0xf bank_mask:0xf
    s_nop 1
    v_add_f32_dpp v108, v108, v108 row_ror:1 row_mask:0xf bank_mask:0xf
    v_add_f32_dpp v109, v109, v109 row_ror:1 row_mask:0xf bank_mask:0xf
    v_cvt_pk_bf16_f32 v112, v108, v109
    v_lshlrev_b32 v108, 16, v112
    v_and_b32 v109, 0xffff0000, v112
    v_mul_f32 v108, s29, v108
    v_mul_f32 v109, s29, v109
    v_max3_f32 v10, v108, v109, v8
    v_cmp_gt_f32 vcc, v10, v8
    v_sub_f32 v108, v108, v10
    v_sub_f32 v109, v109, v10
    v_exp_f32 v108, v108
    v_exp_f32 v109, v109
    s_cbranch_vccz NORS_30
    v_sub_f32 v11, v8, v10
    v_exp_f32 v11, v11
    v_mov_b32 v8, v10
    v_mul_f32 v9, v9, v11
    v_mul_f32 v32, v32, v11
    v_mul_f32 v33, v33, v11
    v_mul_f32 v34, v34, v11
    v_mul_f32 v35, v35, v11
    v_mul_f32 v36, v36, v11
    v_mul_f32 v37, v37, v11
    v_mul_f32 v38, v38, v11
    v_mul_f32 v39, v39, v11
    v_mul_f32 v40, v40, v11
    v_mul_f32 v41, v41, v11
    v_mul_f32 v42, v42, v11
    v_mul_f32 v43, v43, v11
    v_mul_f32 v44, v44, v11
    v_mul_f32 v45, v45, v11
    v_mul_f32 v46, v46, v11
    v_mul_f32 v47, v47, v11
NORS_30:
    v_cvt_pk_bf16_f32 v96, v108, v109
    v_add_f32 v9, v9, v108
    v_add_f32 v9, v9, v109
    s_waitcnt vmcnt(4)
    s_cmp_lg_u32 s22, 0
    s_cbranch_scc1 W_31
    s_waitcnt vmcnt(2)
W_31:
    v_perm_b32 v100, v212, v208, s72
    v_perm_b32 v101, v212, v208, s73
    v_perm_b32 v102, v213, v209, s72
    v_perm_b32 v103, v213, v209, s73
    v_perm_b32 v104, v214, v210, s72
    v_perm_b32 v105, v214, v210, s73
    v_perm_b32 v106, v215, v211, s72
    v_perm_b32 v107, v215, v211, s73
    s_cmp_eq_u32 s21, 0
    s_cbranch_scc1 I_33
    s_sub_u32 s21, s21, 1
    s_branch I_32
I_33:
    s_cmp_eq_u32 s22, 0
    s_cbranch_scc1 I_32
    buffer_load_dwordx4 v[232:235], v4, s[48:51], s18 offen offset:512 nt
    buffer_load_dwordx4 v[236:239], v4, s[48:51], s18 offen offset:768 nt
I_32:
    v_dot2_f32_bf16 v32, v100, v96, v32
    v_dot2_f32_bf16 v33, v101, v96, v33
    v_dot2_f32_bf16 v34, v102, v96, v34
    v_dot2_f32_bf16 v35, v103, v96, v35
    v_dot2_f32_bf16 v36, v104, v96, v36
    v_dot2_f32_bf16 v37, v105, v96, v37
    v_dot2_f32_bf16 v38, v106, v96, v38
    v_dot2_f32_bf16 v39, v107, v96, v39
    s_waitcnt vmcnt(4)
    s_cmp_lg_u32 s22, 0
    s_cbranch_scc1 W_34
    s_waitcnt vmcnt(0)
W_34:
    v_perm_b32 v100, v220, v216, s72
    v_perm_b32 v101, v220, v216, s73
    v_perm_b32 v102, v221, v217, s72
    v_perm_b32 v103, v221, v217, s73
    v_perm_b32 v104, v222, v218, s72
    v_perm_b32 v105, v222, v218, s73
    v_perm_b32 v106, v223, v219, s72
    v_perm_b32 v107, v223, v219, s73
    s_cmp_eq_u32 s21, 0
    s_cbranch_scc1 I_36
    s_sub_u32 s21, s21, 1
    s_branch I_35
I_36:
    s_cmp_eq_u32 s22, 0
    s_cbranch_scc1 I_35
    buffer_load_dwordx4 v[240:243], v4, s[52:55], s18 offen offset:0 nt
    buffer_load_dwordx4 v[244:247], v4, s[52:55], s18 offen offset:512 nt
I_35:
    v_dot2_f32_bf16 v40, v100, v96, v40
    v_dot2_f32_bf16 v41, v101, v96, v41
    v_dot2_f32_bf16 v42, v102, v96, v42
    v_dot2_f32_bf16 v43, v103, v96, v43
    v_dot2_f32_bf16 v44, v104, v96, v44
    v_dot2_f32_bf16 v45, v105, v96, v45
    v_dot2_f32_bf16 v46, v106, v96, v46
    v_dot2_f32_bf16 v47, v107, v96, v47
    s_cmp_eq_u32 s22, 0
    s_cbranch_scc1 A_DONE
    s_mov_b32 s17, s18
    s_mov_b64 exec, 1
    s_cmp_lg_u32 s27, 0
    s_cbranch_scc1 GR_37
    ds_add_rtn_u32 v6, v5, v7
    s_branch GR_38
GR_37:
    v_mov_b32 v6, 1
    buffer_atomic_add v6, off, s[60:63], s26 sc0 sc1
GR_38:
    s_mov_b64 exec, -1
    s_waitcnt vmcnt(4)
    v_dot2_f32_bf16 v108, v224, v16, 0
    v_dot2_f32_bf16 v112, v228, v20, 0
    v_dot2_f32_bf16 v108, v225, v17, v108
    v_dot2_f32_bf16 v112, v229, v21, v112
    v_dot2_f32_bf16 v108, v226, v18, v108
    v_dot2_f32_bf16 v112, v230, v22, v112
    v_dot2_f32_bf16 v108, v227, v19, v108
    v_dot2_f32_bf16 v112, v231, v23, v112
    s_cmp_eq_u32 s21, 0
    s_cbranch_scc1 I_40
    s_sub_u32 s21, s21, 1
    s_branch I_39
I_40:
    buffer_load_dwordx4 v[248:251], v4, s[52:55], s17 offen offset:256 nt
    buffer_load_dwordx4 v[252:255], v4, s[52:55], s17 offen offset:768 nt
I_39:
    s_waitcnt vmcnt(4)
    v_dot2_f32_bf16 v109, v232, v16, 0
    v_dot2_f32_bf16 v113, v236, v20, 0
    v_dot2_f32_bf16 v109, v233, v17, v109
    v_dot2_f32_bf16 v113, v237, v21, v113
    v_dot2_f32_bf16 v109, v234, v18, v109
    v_dot2_f32_bf16 v113, v238, v22, v113
    v_dot2_f32_bf16 v109, v235, v19, v109
    v_dot2_f32_bf16 v113, v239, v23, v113
    s_waitcnt vmcnt(2) lgkmcnt(0)
    v_readfirstlane_b32 s23, v6
    s_cmp_lg_u32 s27, 0
    s_cbranch_scc1 RG_41
    s_add_u32 s98, s23, 8
    s_cmp_ge_u32 s98, s19
    s_cselect_b32 s27, 1, 0
    s_cmp_lt_u32 s23, s19
    s_cbranch_scc1 RF_42
    s_mov_b64 exec, 1
    v_mov_b32 v6, 1
    buffer_atomic_add v6, off, s[60:63], s26 sc0 sc1
    s_mov_b64 exec, -1
    s_waitcnt vmcnt(0)
    v_readfirstlane_b32 s23, v6
RG_41:
    s_min_u32 s23, s23, 4096
    s_add_u32 s23, s23, 384
    s_cmp_lt_u32 s23, 512
    s_cselect_b32 s22, 1, 0
RF_42:
    s_lshl_b32 s18, s23, 12
    s_add_u32 s18, s18, s20
    s_cmp_eq_u32 s21, 0
    s_cbranch_scc1 I_45
    s_sub_u32 s21, s21, 1
    s_branch I_44
I_45:
    s_cmp_eq_u32 s22, 0
    s_cbranch_scc1 I_44
    buffer_load_dwordx4 v[192:195], v4, s[48:51], s18 offen offset:0 nt
    buffer_load_dwordx4 v[196:199], v4, s[48:51], s18 offen offset:256 nt
I_44:
    s_nop 2
    v_add_f32 v108, v108, v112
    v_add_f32 v109, v109, v113
    s_nop 1
    v_add_f32_dpp v108, v108, v108 row_ror:8 row_mask:0xf bank_mask:0xf
    v_add_f32_dpp v109, v109, v109 row_ror:8 row_mask:0xf bank_mask:0xf
    s_nop 1
    v_add_f32_dpp v108, v108, v108 row_ror:4 row_mask:0xf bank_mask:0xf
    v_add_f32_dpp v109, v109, v109 row_ror:4 row_mask:0xf bank_mask:0xf
    s_nop 1
    v_add_f32_dpp v108, v108, v108 row_ror:2 row_mask:0xf bank_mask:0xf
    v_add_f32_dpp v109, v109, v109 row_ror:2 row_mask:0xf bank_mask:0xf
    s_nop 1
    v_add_f32_dpp v108, v108, v108 row_ror:1 row_mask:0xf bank_mask:0xf
    v_add_f32_dpp v109, v109, v109 row_ror:1 row_mask:0xf bank_mask:0xf
    v_cvt_pk_bf16_f32 v112, v108, v109
    v_lshlrev_b32 v108, 16, v112
    v_and_b32 v109, 0xffff0000, v112
    v_mul_f32 v108, s29, v108
    v_mul_f32 v109, s29, v109
    v_max3_f32 v10, v108, v109, v8
    v_cmp_gt_f32 vcc, v10, v8
    v_sub_f32 v108, v108, v10
    v_sub_f32 v109, v109, v10
    v_exp_f32 v108, v108
    v_exp_f32 v109, v109
    s_cbranch_vccz NORS_46
    v_sub_f32 v11, v8, v10
    v_exp_f32 v11, v11
    v_mov_b32 v8, v10
    v_mul_f32 v9, v9, v11
    v_mul_f32 v32, v32, v11
    v_mul_f32 v33, v33, v11
    v_mul_f32 v34, v34, v11
    v_mul_f32 v35, v35, v11
    v_mul_f32 v36, v36, v11
    v_mul_f32 v37, v37, v11
    v_mul_f32 v38, v38, v11
    v_mul_f32 v39, v39, v11
    v_mul_f32 v40, v40, v11
    v_mul_f32 v41, v41, v11
    v_mul_f32 v42, v42, v11
    v_mul_f32 v43, v43, v11
    v_mul_f32 v44, v44, v11
    v_mul_f32 v45, v45, v11
    v_mul_f32 v46, v46, v11
    v_mul_f32 v47, v47, v11
NORS_46:
    v_cvt_pk_bf16_f32 v96, v108, v109
    v_add_f32 v9, v9, v108
    v_add_f32 v9, v9, v109
    s_waitcnt vmcnt(4)
    s_cmp_lg_u32 s22, 0
    s_cbranch_scc1 W_47
    s_waitcnt vmcnt(2)
W_47:
    v_perm_b32 v100, v244, v240, s72
    v_perm_b32 v101, v244, v240, s73
    v_perm_b32 v102, v245, v241, s72
    v_perm_b32 v103, v245, v241, s73
    v_perm_b32 v104, v246, v242, s72
    v_perm_b32 v105, v246, v242, s73
    v_perm_b32 v106, v247, v243, s72
    v_perm_b32 v107, v247, v243, s73
    s_cmp_eq_u32 s21, 0
    s_cbranch_scc1 I_49
    s_sub_u32 s21, s21, 1
    s_branch I_48
I_49:
    s_cmp_eq_u32 s22, 0
    s_cbranch_scc1 I_48
    buffer_load_dwordx4 v[200:203], v4, s[48:51], s18 offen offset:512 nt
    buffer_load_dwordx4 v[204:207], v4, s[48:51], s18 offen offset:768 nt
I_48:
    v_dot2_f32_bf16 v32, v100, v96, v32
    v_dot2_f32_bf16 v33, v101, v96, v33
    v_dot2_f32_bf16 v34, v102, v96, v34
    v_dot2_f32_bf16 v35, v103, v96, v35
    v_dot2_f32_bf16 v36, v104, v96, v36
    v_dot2_f32_bf16 v37, v105, v96, v37
    v_dot2_f32_bf16 v38, v106, v96, v38
    v_dot2_f32_bf16 v39, v107, v96, v39
    s_waitcnt vmcnt(4)
    s_cmp_lg_u32 s22, 0
    s_cbranch_scc1 W_50
    s_waitcnt vmcnt(0)
W_50:
    v_perm_b32 v100, v252, v248, s72
    v_perm_b32 v101, v252, v248, s73
    v_perm_b32 v102, v253, v249, s72
    v_perm_b32 v103, v253, v249, s73
    v_perm_b32 v104, v254, v250, s72
    v_perm_b32 v105, v254, v250, s73
    v_perm_b32 v106, v255, v251, s72
    v_perm_b32 v107, v255, v251, s73
    s_cmp_eq_u32 s21, 0
    s_cbranch_scc1 I_52
    s_sub_u32 s21, s21, 1
    s_branch I_51
I_52:
    s_cmp_eq_u32 s22, 0
    s_cbranch_scc1 I_51
    buffer_load_dwordx4 v[208:211], v4, s[52:55], s18 offen offset:0 nt
    buffer_load_dwordx4 v[212:215], v4, s[52:55], s18 offen offset:512 nt
I_51:
    v_dot2_f32_bf16 v40, v100, v96, v40
    v_dot2_f32_bf16 v41, v101, v96, v41
    v_dot2_f32_bf16 v42, v102, v96, v42
    v_dot2_f32_bf16 v43, v103, v96, v43
    v_dot2_f32_bf16 v44, v104, v96, v44
    v_dot2_f32_bf16 v45, v105, v96, v45
    v_dot2_f32_bf16 v46, v106, v96, v46
    v_dot2_f32_bf16 v47, v107, v96, v47
    s_cmp_eq_u32 s22, 0
    s_cbranch_scc1 A_DONE
    s_mov_b32 s17, s18
    s_branch A_LOOP
A_DONE:
    s_waitcnt lgkmcnt(0)
    v_mov_b32 v10, v8
    v_mov_b32 v12, v10
    s_nop 1
    v_permlane16_swap_b32 v12, v10
    s_nop 1
    v_max_f32 v10, v10, v12
    v_mov_b32 v12, v10
    s_nop 1
    v_permlane32_swap_b32 v12, v10
    s_nop 1
    v_max_f32 v10, v10, v12
    v_sub_f32 v11, v8, v10
    v_exp_f32 v11, v11
    s_nop 0
    v_mul_f32 v9, v9, v11
    v_mul_f32 v32, v32, v11
    v_mul_f32 v33, v33, v11
    v_mul_f32 v34, v34, v11
    v_mul_f32 v35, v35, v11
    v_mul_f32 v36, v36, v11
    v_mul_f32 v37, v37, v11
    v_mul_f32 v38, v38, v11
    v_mul_f32 v39, v39, v11
    v_mul_f32 v40, v40, v11
    v_mul_f32 v41, v41, v11
    v_mul_f32 v42, v42, v11
    v_mul_f32 v43, v43, v11
    v_mul_f32 v44, v44, v11
    v_mul_f32 v45, v45, v11
    v_mul_f32 v46, v46, v11
    v_mul_f32 v47, v47, v11
    v_mov_b32 v11, v9
    v_mov_b32 v12, v11
    s_nop 1
    v_permlane16_swap_b32 v12, v11
    s_nop 1
    v_add_f32 v11, v11, v12
    v_mov_b32 v12, v11
    s_nop 1
    v_permlane32_swap_b32 v12, v11
    s_nop 1
    v_add_f32 v11, v11, v12
    s_nop 1
    v_permlane32_swap_b32 v32, v40
    v_permlane32_swap_b32 v33, v41
    v_permlane32_swap_b32 v34, v42
    v_permlane32_swap_b32 v35, v43
    v_permlane32_swap_b32 v36, v44
    v_permlane32_swap_b32 v37, v45
    v_permlane32_swap_b32 v38, v46
    v_permlane32_swap_b32 v39, v47
    s_nop 1
    v_add_f32 v32, v32, v40
    v_add_f32 v33, v33, v41
    v_add_f32 v34, v34, v42
    v_add_f32 v35, v35, v43
    v_add_f32 v36, v36, v44
    v_add_f32 v37, v37, v45
    v_add_f32 v38, v38, v46
    v_add_f32 v39, v39, v47
    s_nop 1
    v_permlane16_swap_b32 v32, v36
    v_permlane16_swap_b32 v33, v37
    v_permlane16_swap_b32 v34, v38
    v_permlane16_swap_b32 v35, v39
    s_nop 1
    v_add_f32 v32, v32, v36
    v_add_f32 v33, v33, v37
    v_add_f32 v34, v34, v38
    v_add_f32 v35, v35, v39
    v_lshrrev_b32 v12, 1, v3
    v_lshlrev_b32 v12, 9, v12
    v_and_b32 v13, 1, v3
    v_lshl_add_u32 v12, v13, 4, v12
    v_lshl_add_u32 v12, v2, 5, v12
    s_lshl_b32 s98, s3, 10
    v_add_u32 v12, s98, v12
    ds_write_b128 v12, v[32:35] offset:0
    s_lshl_b32 s98, s3, 3
    v_mov_b32 v12, s98
    s_mov_b64 exec, 1
    ds_write_b64 v12, v[10:11] offset:8192
    s_mov_b64 exec, -1
    s_waitcnt lgkmcnt(0)
    s_barrier
    s_cmp_ge_u32 s3, 4
    s_cbranch_scc1 ACOMB_53
    v_lshlrev_b32 v12, 2, v0
    v_mov_b32 v13, 0
    ds_read_b32 v32, v12 offset:0
    ds_read_b32 v33, v12 offset:1024
    ds_read_b32 v34, v12 offset:2048
    ds_read_b32 v35, v12 offset:3072
    ds_read_b32 v36, v12 offset:4096
    ds_read_b32 v37, v12 offset:5120
    ds_read_b32 v38, v12 offset:6144
    ds_read_b32 v39, v12 offset:7168
    ds_read_b128 v[48:51], v13 offset:8192
    ds_read_b128 v[52:55], v13 offset:8208
    ds_read_b128 v[56:59], v13 offset:8224
    ds_read_b128 v[60:63], v13 offset:8240
    s_waitcnt lgkmcnt(0)
    v_max3_f32 v10, v48, v50, v52
    v_max3_f32 v10, v10, v54, v56
    v_max3_f32 v10, v10, v58, v60
    v_max_f32 v10, v10, v62
    v_sub_f32 v48, v48, v10
    v_sub_f32 v50, v50, v10
    v_sub_f32 v52, v52, v10
    v_sub_f32 v54, v54, v10
    v_sub_f32 v56, v56, v10
    v_sub_f32 v58, v58, v10
    v_sub_f32 v60, v60, v10
    v_sub_f32 v62, v62, v10
    v_exp_f32 v48, v48
    v_exp_f32 v50, v50
    v_exp_f32 v52, v52
    v_exp_f32 v54, v54
    v_exp_f32 v56, v56
    v_exp_f32 v58, v58
    v_exp_f32 v60, v60
    v_exp_f32 v62, v62
    s_nop 0
    v_mul_f32 v14, v32, v48
    v_mul_f32 v11, v49, v48
    v_fmac_f32 v14, v33, v50
    v_fmac_f32 v11, v51, v50
    v_fmac_f32 v14, v34, v52
    v_fmac_f32 v11, v53, v52
    v_fmac_f32 v14, v35, v54
    v_fmac_f32 v11, v55, v54
    v_fmac_f32 v14, v36, v56
    v_fmac_f32 v11, v57, v56
    v_fmac_f32 v14, v37, v58
    v_fmac_f32 v11, v59, v58
    v_fmac_f32 v14, v38, v60
    v_fmac_f32 v11, v61, v60
    v_fmac_f32 v14, v39, v62
    v_fmac_f32 v11, v63, v62
    s_lshl_b32 s98, s7, 12
    s_add_u32 s98, s98, 6291456
    v_mov_b32 v15, s4
    v_lshlrev_b32 v12, 3, v0
    buffer_store_dwordx2 v[14:15], v12, s[60:63], s98 offen sc1
    s_cmp_lg_u32 s3, 0
    s_cbranch_scc1 ACOMB_53
    v_mov_b32 v32, v10
    v_mov_b32 v33, s4
    v_mov_b32 v34, v11
    v_mov_b32 v35, s4
    s_mov_b64 exec, 1
    buffer_store_dwordx4 v[32:35], off, s[60:63], s98 offset:2048 sc1
    s_mov_b64 exec, -1
ACOMB_53:
    s_cmp_lg_u32 s3, 0
    s_cbranch_scc1 FLAG_54
    s_sub_u32 s98, s7, 0
    s_lshl_b32 s98, s98, 2
    s_add_u32 s98, s98, 798720
    v_mov_b32 v13, s4
    s_mov_b64 exec, 1
    buffer_store_dword v13, off, s[60:63], s98 sc1
    s_mov_b64 exec, -1
FLAG_54:
    s_cmp_ge_u32 s6, 8
    s_cbranch_scc1 L_END
    s_cmp_ge_u32 s6, 4
    s_cbranch_scc1 L_FINAL
    v_perm_b32 v12, v164, v160, s72
    v_perm_b32 v164, v164, v160, s73
    v_mov_b32 v160, v12
    v_perm_b32 v12, v165, v161, s72
    v_perm_b32 v165, v165, v161, s73
    v_mov_b32 v161, v12
    v_perm_b32 v12, v166, v162, s72
    v_perm_b32 v166, v166, v162, s73
    v_mov_b32 v162, v12
    v_perm_b32 v12, v167, v163, s72
    v_perm_b32 v167, v167, v163, s73
    v_mov_b32 v163, v12
    v_perm_b32 v12, v172, v168, s72
    v_perm_b32 v172, v172, v168, s73
    v_mov_b32 v168, v12
    v_perm_b32 v12, v173, v169, s72
    v_perm_b32 v173, v173, v169, s73
    v_mov_b32 v169, v12
    v_perm_b32 v12, v174, v170, s72
    v_perm_b32 v174, v174, v170, s73
    v_mov_b32 v170, v12
    v_perm_b32 v12, v175, v171, s72
    v_perm_b32 v175, v175, v171, s73
    v_mov_b32 v171, v12
    v_perm_b32 v12, v180, v176, s72
    v_perm_b32 v180, v180, v176, s73
    v_mov_b32 v176, v12
    v_perm_b32 v12, v181, v177, s72
    v_perm_b32 v181, v181, v177, s73
    v_mov_b32 v177, v12
    v_perm_b32 v12, v182, v178, s72
    v_perm_b32 v182, v182, v178, s73
    v_mov_b32 v178, v12
    v_perm_b32 v12, v183, v179, s72
    v_perm_b32 v183, v183, v179, s73
    v_mov_b32 v179, v12
    v_perm_b32 v12, v188, v184, s72
    v_perm_b32 v188, v188, v184, s73
    v_mov_b32 v184, v12
    v_perm_b32 v12, v189, v185, s72
    v_perm_b32 v189, v189, v185, s73
    v_mov_b32 v185, v12
    v_perm_b32 v12, v190, v186, s72
    v_perm_b32 v190, v190, v186, s73
    v_mov_b32 v186, v12
    v_perm_b32 v12, v191, v187, s72
    v_perm_b32 v191, v191, v187, s73
    v_mov_b32 v187, v12
    s_mul_i32 s99, s5, 48
    s_add_u32 s99, s99, 798720
    s_cmp_lg_u32 s3, 0
    s_cbranch_scc1 POLLOK_56
    v_lshlrev_b32 v12, 2, v1
    s_mov_b32 s98, s99
    s_mov_b32 exec_lo, 0xfff
    s_mov_b32 exec_hi, 0x0
    s_mov_b32 s75, 0
POLL_55:
    buffer_load_dword v13, v12, s[60:63], s98 offen sc1
    s_waitcnt vmcnt(0)
    v_cmp_eq_u32 vcc, s4, v13
    s_cmp_eq_u64 vcc, exec
    s_cbranch_scc1 POLLOK_56
    s_add_u32 s75, s75, 1
    s_cmp_gt_u32 s75, 400000
    s_cbranch_scc1 POLLOK_56
    s_sleep 1
    s_branch POLL_55
POLLOK_56:
    s_mov_b64 exec, -1
    s_barrier
    s_cmp_ge_u32 s3, 2
    s_cbranch_scc1 ACB_57
    s_mov_b32 s75, 0
    s_lshl_b32 s99, s6, 9
    v_lshlrev_b32 v12, 3, v1
    v_add_u32 v12, s99, v12
ACL_58:
    s_mul_i32 s98, s5, 12
    s_mul_i32 s99, s3, 6
    s_add_u32 s98, s98, s99
    s_lshl_b32 s98, s98, 12
    s_add_u32 s98, s98, 6291456
    buffer_load_dwordx2 v[32:33], v12, s[60:63], s98 offen sc1
    buffer_load_dwordx4 v[80:83], off, s[60:63], s98 offset:2048 sc1
    s_add_u32 s98, s98, 4096
    buffer_load_dwordx2 v[34:35], v12, s[60:63], s98 offen sc1
    buffer_load_dwordx4 v[84:87], off, s[60:63], s98 offset:2048 sc1
    s_add_u32 s98, s98, 4096
    buffer_load_dwordx2 v[36:37], v12, s[60:63], s98 offen sc1
    buffer_load_dwordx4 v[88:91], off, s[60:63], s98 offset:2048 sc1
    s_add_u32 s98, s98, 4096
    buffer_load_dwordx2 v[38:39], v12, s[60:63], s98 offen sc1
    buffer_load_dwordx4 v[92:95], off, s[60:63], s98 offset:2048 sc1
    s_add_u32 s98, s98, 4096
    buffer_load_dwordx2 v[40:41], v12, s[60:63], s98 offen sc1
    buffer_load_dwordx4 v[96:99], off, s[60:63], s98 offset:2048 sc1
    s_add_u32 s98, s98, 4096
    buffer_load_dwordx2 v[42:43], v12, s[60:63], s98 offen sc1
    buffer_load_dwordx4 v[100:103], off, s[60:63], s98 offset:2048 sc1
    s_add_u32 s98, s98, 4096
    s_waitcnt vmcnt(0)
    v_xor_b32 v13, s4, v33
    v_xor_b32 v14, s4, v35
    v_or_b32 v13, v13, v14
    v_xor_b32 v14, s4, v37
    v_or_b32 v13, v13, v14
    v_xor_b32 v14, s4, v39
    v_or_b32 v13, v13, v14
    v_xor_b32 v14, s4, v41
    v_or_b32 v13, v13, v14
    v_xor_b32 v14, s4, v43
    v_or_b32 v13, v13, v14
    v_xor_b32 v14, s4, v81
    v_or_b32 v13, v13, v14
    v_xor_b32 v14, s4, v83
    v_or_b32 v13, v13, v14
    v_xor_b32 v14, s4, v85
    v_or_b32 v13, v13, v14
    v_xor_b32 v14, s4, v87
    v_or_b32 v13, v13, v14
    v_xor_b32 v14, s4, v89
    v_or_b32 v13, v13, v14
    v_xor_b32 v14, s4, v91
    v_or_b32 v13, v13, v14
    v_xor_b32 v14, s4, v93
    v_or_b32 v13, v13, v14
    v_xor_b32 v14, s4, v95
    v_or_b32 v13, v13, v14
    v_xor_b32 v14, s4, v97
    v_or_b32 v13, v13, v14
    v_xor_b32 v14, s4, v99
    v_or_b32 v13, v13, v14
    v_xor_b32 v14, s4, v101
    v_or_b32 v13, v13, v14
    v_xor_b32 v14, s4, v103
    v_or_b32 v13, v13, v14
    v_cmp_eq_u32 vcc, 0, v13
    s_cmp_eq_u64 vcc, exec
    s_cbranch_scc1 ACOK_59
    s_add_u32 s75, s75, 1
    s_cmp_gt_u32 s75, 400000
    s_cbranch_scc0 ACL_58
ACOK_59:
    v_max3_f32 v10, v80, v84, v88
    v_max3_f32 v10, v10, v92, v96
    v_max_f32 v10, v10, v100
    v_sub_f32 v80, v80, v10
    v_sub_f32 v84, v84, v10
    v_sub_f32 v88, v88, v10
    v_sub_f32 v92, v92, v10
    v_sub_f32 v96, v96, v10
    v_sub_f32 v100, v100, v10
    v_exp_f32 v80, v80
    v_exp_f32 v84, v84
    v_exp_f32 v88, v88
    v_exp_f32 v92, v92
    v_exp_f32 v96, v96
    v_exp_f32 v100, v100
    s_nop 0
    v_mul_f32 v14, v32, v80
    v_mul_f32 v11, v82, v80
    v_fmac_f32 v14, v34, v84
    v_fmac_f32 v11, v86, v84
    v_fmac_f32 v14, v36, v88
    v_fmac_f32 v11, v90, v88
    v_fmac_f32 v14, v38, v92
    v_fmac_f32 v11, v94, v92
    v_fmac_f32 v14, v40, v96
    v_fmac_f32 v11, v98, v96
    v_fmac_f32 v14, v42, v100
    v_fmac_f32 v11, v102, v100
    v_rcp_f32 v11, v11
    s_nop 0
    v_mul_f32 v14, v14, v11
    v_cvt_pk_bf16_f32 v14, v14, v14
    v_lshlrev_b32 v12, 1, v0
    ds_write_b16 v12, v14 offset:8704
ACB_57:
    s_waitcnt lgkmcnt(0)
    s_barrier
    s_mul_i32 s8, s3, 16
    s_add_u32 s8, s8, 8704
    v_mov_b32 v12, s8
    ds_read_b128 v[32:35], v12 offset:0
    ds_read_b128 v[36:39], v12 offset:128
    v_mov_b32 v48, 0
    v_mov_b32 v49, 0
    v_mov_b32 v50, 0
    v_mov_b32 v51, 0
    v_mov_b32 v52, 0
    v_mov_b32 v53, 0
    v_mov_b32 v54, 0
    v_mov_b32 v55, 0
    v_mov_b32 v56, 0
    v_mov_b32 v57, 0
    v_mov_b32 v58, 0
    v_mov_b32 v59, 0
    v_mov_b32 v60, 0
    v_mov_b32 v61, 0
    v_mov_b32 v62, 0
    v_mov_b32 v63, 0
    s_waitcnt lgkmcnt(0)
    v_dot2_f32_bf16 v48, v160, v32, v48
    v_dot2_f32_bf16 v49, v164, v32, v49
    v_dot2_f32_bf16 v50, v161, v32, v50
    v_dot2_f32_bf16 v51, v165, v32, v51
    v_dot2_f32_bf16 v52, v162, v32, v52
    v_dot2_f32_bf16 v53, v166, v32, v53
    v_dot2_f32_bf16 v54, v163, v32, v54
    v_dot2_f32_bf16 v55, v167, v32, v55
    v_dot2_f32_bf16 v56, v160, v36, v56
    v_dot2_f32_bf16 v57, v164, v36, v57
    v_dot2_f32_bf16 v58, v161, v36, v58
    v_dot2_f32_bf16 v59, v165, v36, v59
    v_dot2_f32_bf16 v60, v162, v36, v60
    v_dot2_f32_bf16 v61, v166, v36, v61
    v_dot2_f32_bf16 v62, v163, v36, v62
    v_dot2_f32_bf16 v63, v167, v36, v63
    v_dot2_f32_bf16 v48, v168, v33, v48
    v_dot2_f32_bf16 v49, v172, v33, v49
    v_dot2_f32_bf16 v50, v169, v33, v50
    v_dot2_f32_bf16 v51, v173, v33, v51
    v_dot2_f32_bf16 v52, v170, v33, v52
    v_dot2_f32_bf16 v53, v174, v33, v53
    v_dot2_f32_bf16 v54, v171, v33, v54
    v_dot2_f32_bf16 v55, v175, v33, v55
    v_dot2_f32_bf16 v56, v168, v37, v56
    v_dot2_f32_bf16 v57, v172, v37, v57
    v_dot2_f32_bf16 v58, v169, v37, v58
    v_dot2_f32_bf16 v59, v173, v37, v59
    v_dot2_f32_bf16 v60, v170, v37, v60
    v_dot2_f32_bf16 v61, v174, v37, v61
    v_dot2_f32_bf16 v62, v171, v37, v62
    v_dot2_f32_bf16 v63, v175, v37, v63
    v_dot2_f32_bf16 v48, v176, v34, v48
    v_dot2_f32_bf16 v49, v180, v34, v49
    v_dot2_f32_bf16 v50, v177, v34, v50
    v_dot2_f32_bf16 v51, v181, v34, v51
    v_dot2_f32_bf16 v52, v178, v34, v52
    v_dot2_f32_bf16 v53, v182, v34, v53
    v_dot2_f32_bf16 v54, v179, v34, v54
    v_dot2_f32_bf16 v55, v183, v34, v55
    v_dot2_f32_bf16 v56, v176, v38, v56
    v_dot2_f32_bf16 v57, v180, v38, v57
    v_dot2_f32_bf16 v58, v177, v38, v58
    v_dot2_f32_bf16 v59, v181, v38, v59
    v_dot2_f32_bf16 v60, v178, v38, v60
    v_dot2_f32_bf16 v61, v182, v38, v61
    v_dot2_f32_bf16 v62, v179, v38, v62
    v_dot2_f32_bf16 v63, v183, v38, v63
    v_dot2_f32_bf16 v48, v184, v35, v48
    v_dot2_f32_bf16 v49, v188, v35, v49
    v_dot2_f32_bf16 v50, v185, v35, v50
    v_dot2_f32_bf16 v51, v189, v35, v51
    v_dot2_f32_bf16 v52, v186, v35, v52
    v_dot2_f32_bf16 v53, v190, v35, v53
    v_dot2_f32_bf16 v54, v187, v35, v54
    v_dot2_f32_bf16 v55, v191, v35, v55
    v_dot2_f32_bf16 v56, v184, v39, v56
    v_dot2_f32_bf16 v57, v188, v39, v57
    v_dot2_f32_bf16 v58, v185, v39, v58
    v_dot2_f32_bf16 v59, v189, v39, v59
    v_dot2_f32_bf16 v60, v186, v39, v60
    v_dot2_f32_bf16 v61, v190, v39, v61
    v_dot2_f32_bf16 v62, v187, v39, v62
    v_dot2_f32_bf16 v63, v191, v39, v63
    s_lshl_b32 s32, s5, 2
    s_add_u32 s32, s32, s6
    s_branch L_YPUB
L_ROLE_B:
    s_lshl_b32 s98, s3, 2
    s_add_u32 s98, s98, 0
    s_and_b32 s98, s98, 15
    s_and_b32 s99, s98, 7
    s_lshl_b32 s99, s99, 1
    s_lshr_b32 s98, s98, 3
    s_or_b32 s98, s98, s99
    v_xor_b32 v8, s98, v1
    v_lshlrev_b32 v8, 4, v8
    s_lshl_b32 s98, s3, 2
    s_add_u32 s98, s98, 1
    s_and_b32 s98, s98, 15
    s_and_b32 s99, s98, 7
    s_lshl_b32 s99, s99, 1
    s_lshr_b32 s98, s98, 3
    s_or_b32 s98, s98, s99
    v_xor_b32 v9, s98, v1
    v_lshlrev_b32 v9, 4, v9
    s_lshl_b32 s98, s3, 2
    s_add_u32 s98, s98, 2
    s_and_b32 s98, s98, 15
    s_and_b32 s99, s98, 7
    s_lshl_b32 s99, s99, 1
    s_lshr_b32 s98, s98, 3
    s_or_b32 s98, s98, s99
    v_xor_b32 v10, s98, v1
    v_lshlrev_b32 v10, 4, v10
    s_lshl_b32 s98, s3, 2
    s_add_u32 s98, s98, 3
    s_and_b32 s98, s98, 15
    s_and_b32 s99, s98, 7
    s_lshl_b32 s99, s99, 1
    s_lshr_b32 s98, s98, 3
    s_or_b32 s98, s98, s99
    v_xor_b32 v11, s98, v1
    v_lshlrev_b32 v11, 4, v11
    s_lshl_b32 s98, s24, 12
    s_lshl_b32 s99, s25, 7
    s_add_u32 s98, s98, s99
    s_lshl_b32 s99, s3, 2
    s_add_u32 s98, s98, s99
    s_lshl_b32 s27, s98, 11
    s_lshl_b32 s28, s3, 13
    s_add_u32 s98, s28, 0
    s_mov_b32 m0, s98
    s_add_u32 s99, s27, 0
    buffer_load_dwordx4 v8, s[48:51], s99 offen nt lds
    s_add_u32 s98, s28, 1024
    s_mov_b32 m0, s98
    s_add_u32 s99, s27, 1024
    buffer_load_dwordx4 v8, s[48:51], s99 offen nt lds
    s_add_u32 s98, s28, 2048
    s_mov_b32 m0, s98
    s_add_u32 s99, s27, 2048
    buffer_load_dwordx4 v9, s[48:51], s99 offen nt lds
    s_add_u32 s98, s28, 3072
    s_mov_b32 m0, s98
    s_add_u32 s99, s27, 3072
    buffer_load_dwordx4 v9, s[48:51], s99 offen nt lds
    s_add_u32 s98, s28, 4096
    s_mov_b32 m0, s98
    s_add_u32 s99, s27, 4096
    buffer_load_dwordx4 v10, s[48:51], s99 offen nt lds
    s_add_u32 s98, s28, 5120
    s_mov_b32 m0, s98
    s_add_u32 s99, s27, 5120
    buffer_load_dwordx4 v10, s[48:51], s99 offen nt lds
    s_add_u32 s98, s28, 6144
    s_mov_b32 m0, s98
    s_add_u32 s99, s27, 6144
    buffer_load_dwordx4 v11, s[48:51], s99 offen nt lds
    s_add_u32 s98, s28, 7168
    s_mov_b32 m0, s98
    s_add_u32 s99, s27, 7168
    buffer_load_dwordx4 v11, s[48:51], s99 offen nt lds
    s_add_u32 s98, s28, 65536
    s_mov_b32 m0, s98
    s_add_u32 s99, s27, 65536
    buffer_load_dwordx4 v8, s[48:51], s99 offen nt lds
    s_add_u32 s98, s28, 66560
    s_mov_b32 m0, s98
    s_add_u32 s99, s27, 66560
    buffer_load_dwordx4 v8, s[48:51], s99 offen nt lds
    s_add_u32 s98, s28, 67584
    s_mov_b32 m0, s98
    s_add_u32 s99, s27, 67584
    buffer_load_dwordx4 v9, s[48:51], s99 offen nt lds
    s_add_u32 s98, s28, 68608
    s_mov_b32 m0, s98
    s_add_u32 s99, s27, 68608
    buffer_load_dwordx4 v9, s[48:51], s99 offen nt lds
    s_add_u32 s98, s28, 69632
    s_mov_b32 m0, s98
    s_add_u32 s99, s27, 69632
    buffer_load_dwordx4 v10, s[48:51], s99 offen nt lds
    s_add_u32 s98, s28, 70656
    s_mov_b32 m0, s98
    s_add_u32 s99, s27, 70656
    buffer_load_dwordx4 v10, s[48:51], s99 offen nt lds
    s_add_u32 s98, s28, 71680
    s_mov_b32 m0, s98
    s_add_u32 s99, s27, 71680
    buffer_load_dwordx4 v11, s[48:51], s99 offen nt lds
    s_add_u32 s98, s28, 72704
    s_mov_b32 m0, s98
    s_add_u32 s99, s27, 72704
    buffer_load_dwordx4 v11, s[48:51], s99 offen nt lds
    s_add_u32 s99, s27, 131072
    buffer_load_dwordx4 v[192:195], v8, s[48:51], s99 offen nt
    s_add_u32 s99, s27, 132096
    buffer_load_dwordx4 v[196:199], v8, s[48:51], s99 offen nt
    s_add_u32 s99, s27, 133120
    buffer_load_dwordx4 v[200:203], v9, s[48:51], s99 offen nt
    s_add_u32 s99, s27, 134144
    buffer_load_dwordx4 v[204:207], v9, s[48:51], s99 offen nt
    s_add_u32 s99, s27, 135168
    buffer_load_dwordx4 v[208:211], v10, s[48:51], s99 offen nt
    s_add_u32 s99, s27, 136192
    buffer_load_dwordx4 v[212:215], v10, s[48:51], s99 offen nt
    s_add_u32 s99, s27, 137216
    buffer_load_dwordx4 v[216:219], v11, s[48:51], s99 offen nt
    s_add_u32 s99, s27, 138240
    buffer_load_dwordx4 v[220:223], v11, s[48:51], s99 offen nt
    s_add_u32 s99, s27, 196608
    buffer_load_dwordx4 v[224:227], v8, s[48:51], s99 offen nt
    s_add_u32 s99, s27, 197632
    buffer_load_dwordx4 v[228:231], v8, s[48:51], s99 offen nt
    s_add_u32 s99, s27, 198656
    buffer_load_dwordx4 v[232:235], v9, s[48:51], s99 offen nt
    s_add_u32 s99, s27, 199680
    buffer_load_dwordx4 v[236:239], v9, s[48:51], s99 offen nt
    s_add_u32 s99, s27, 200704
    buffer_load_dwordx4 v[240:243], v10, s[48:51], s99 offen nt
    s_add_u32 s99, s27, 201728
    buffer_load_dwordx4 v[244:247], v10, s[48:51], s99 offen nt
    s_add_u32 s99, s27, 202752
    buffer_load_dwordx4 v[248:251], v11, s[48:51], s99 offen nt
    s_add_u32 s99, s27, 203776
    buffer_load_dwordx4 v[252:255], v11, s[48:51], s99 offen nt
    v_lshlrev_b32 v31, 4, v1
    v_add_u32 v31, s28, v31
    v_lshlrev_b32 v30, 17, v3
    v_lshl_add_u32 v30, v2, 4, v30
    s_lshr_b32 s98, s6, 1
    s_lshl_b32 s98, s98, 9
    s_lshl_b32 s99, s3, 6
    s_add_u32 s98, s98, s99
    s_lshl_b32 s98, s98, 13
    s_lshl_b32 s99, s5, 9
    s_add_u32 s98, s98, s99
    s_lshl_b32 s99, s26, 8
    s_add_u32 s34, s98, s99
    v_and_b32 v12, 7, v2
    v_lshlrev_b32 v12, 1, v12
    v_lshrrev_b32 v13, 3, v2
    v_or_b32 v12, v12, v13
    v_lshlrev_b32 v13, 1, v3
    v_xor_b32 v12, v12, v13
    s_lshr_b32 s98, s3, 2
    s_lshl_b32 s98, s98, 15
    s_and_b32 s99, s3, 3
    s_lshl_b32 s99, s99, 9
    s_add_u32 s98, s98, s99
    v_lshlrev_b32 v13, 11, v2
    v_add_u32 v13, s98, v13
    v_xor_b32 v14, 0, v12
    v_lshl_add_u32 v4, v14, 4, v13
    v_xor_b32 v14, 1, v12
    v_lshl_add_u32 v5, v14, 4, v13
    v_xor_b32 v14, 8, v12
    v_lshl_add_u32 v6, v14, 4, v13
    v_xor_b32 v14, 9, v12
    v_lshl_add_u32 v7, v14, 4, v13
    v_lshrrev_b32 v12, 2, v2
    v_lshl_add_u32 v12, v3, 2, v12
    v_and_b32 v13, 7, v12
    v_lshlrev_b32 v13, 1, v13
    v_lshrrev_b32 v14, 3, v12
    v_or_b32 v13, v13, v14
    v_bfe_u32 v14, v2, 1, 1
    v_xor_b32 v13, v13, v14
    v_lshlrev_b32 v12, 11, v12
    v_and_b32 v14, 1, v2
    v_lshl_add_u32 v12, v14, 3, v12
    s_lshl_b32 s98, s3, 8
    v_add_u32 v12, s98, v12
    v_xor_b32 v14, 0, v13
    v_lshl_add_u32 v16, v14, 4, v12
    v_xor_b32 v14, 2, v13
    v_lshl_add_u32 v17, v14, 4, v12
    v_xor_b32 v14, 4, v13
    v_lshl_add_u32 v18, v14, 4, v12
    v_xor_b32 v14, 6, v13
    v_lshl_add_u32 v19, v14, 4, v12
    v_xor_b32 v14, 8, v13
    v_lshl_add_u32 v20, v14, 4, v12
    v_xor_b32 v14, 10, v13
    v_lshl_add_u32 v21, v14, 4, v12
    v_xor_b32 v14, 12, v13
    v_lshl_add_u32 v22, v14, 4, v12
    v_xor_b32 v14, 14, v13
    v_lshl_add_u32 v23, v14, 4, v12
    v_lshlrev_b32 v29, 4, v1
    v_add_u32 v29, 131072, v29
    s_lshl_b32 s98, s3, 10
    v_add_u32 v28, s98, v29
    v_mov_b32 v32, 0
    v_mov_b32 v33, 0
    v_mov_b32 v34, 0
    v_mov_b32 v35, 0
    v_mov_b32 v36, 0
    v_mov_b32 v37, 0
    v_mov_b32 v38, 0
    v_mov_b32 v39, 0
    v_mov_b32 v40, 0
    v_mov_b32 v41, 0
    v_mov_b32 v42, 0
    v_mov_b32 v43, 0
    v_mov_b32 v44, 0
    v_mov_b32 v45, 0
    v_mov_b32 v46, 0
    v_mov_b32 v47, 0
    v_mov_b32 v48, 0
    v_mov_b32 v49, 0
    v_mov_b32 v50, 0
    v_mov_b32 v51, 0
    v_mov_b32 v52, 0
    v_mov_b32 v53, 0
    v_mov_b32 v54, 0
    v_mov_b32 v55, 0
    v_mov_b32 v56, 0
    v_mov_b32 v57, 0
    v_mov_b32 v58, 0
    v_mov_b32 v59, 0
    v_mov_b32 v60, 0
    v_mov_b32 v61, 0
    v_mov_b32 v62, 0
    v_mov_b32 v63, 0
    v_mov_b32 v124, 0xff800000
    v_mov_b32 v125, 0
    s_mov_b32 s29, 0x3db8aa3b
    s_waitcnt vmcnt(32)
    v_readfirstlane_b32 s4, v127
    s_add_u32 s4, s4, 1
    s_cmp_lg_u32 s3, 4
    s_cbranch_scc1 POLLOK_61
    v_lshlrev_b32 v12, 4, v1
    s_mov_b32 s98, 786432
    s_mov_b32 exec_lo, 0xffffffff
    s_mov_b32 exec_hi, 0xffff
    s_mov_b32 s75, 0
POLL_60:
    buffer_load_dwordx4 v[88:91], v12, s[60:63], s98 offen sc1
    s_waitcnt vmcnt(0)
    v_cmp_eq_u32 vcc, s4, v88
    v_cmp_eq_u32 s[78:79], s4, v89
    s_and_b64 vcc, vcc, s[78:79]
    v_cmp_eq_u32 s[78:79], s4, v90
    s_and_b64 vcc, vcc, s[78:79]
    v_cmp_eq_u32 s[78:79], s4, v91
    s_and_b64 vcc, vcc, s[78:79]
    s_cmp_eq_u64 vcc, exec
    s_cbranch_scc1 POLLOK_61
    s_add_u32 s75, s75, 1
    s_cmp_gt_u32 s75, 400000
    s_cbranch_scc1 POLLOK_61
    s_sleep 4
    s_branch POLL_60
POLLOK_61:
    s_mov_b64 exec, -1
    s_barrier
    v_lshlrev_b32 v12, 4, v1
    s_and_b32 s98, s3, 3
    s_lshl_b32 s98, s98, 14
    s_lshl_b32 s99, s24, 16
    s_add_u32 s98, s98, s99
    s_add_u32 s98, s98, 655360
    buffer_load_dwordx4 v[128:131], v12, s[60:63], s98 offen offset:0 sc1
    buffer_load_dwordx4 v[132:135], v12, s[60:63], s98 offen offset:1024 sc1
    buffer_load_dwordx4 v[136:139], v12, s[60:63], s98 offen offset:2048 sc1
    buffer_load_dwordx4 v[140:143], v12, s[60:63], s98 offen offset:3072 sc1
    s_add_u32 s98, s98, 4096
    buffer_load_dwordx4 v[144:147], v12, s[60:63], s98 offen offset:0 sc1
    buffer_load_dwordx4 v[148:151], v12, s[60:63], s98 offen offset:1024 sc1
    buffer_load_dwordx4 v[152:155], v12, s[60:63], s98 offen offset:2048 sc1
    buffer_load_dwordx4 v[156:159], v12, s[60:63], s98 offen offset:3072 sc1
    s_add_u32 s98, s98, 4096
    buffer_load_dwordx4 v[160:163], v12, s[60:63], s98 offen offset:0 sc1
    buffer_load_dwordx4 v[164:167], v12, s[60:63], s98 offen offset:1024 sc1
    buffer_load_dwordx4 v[168:171], v12, s[60:63], s98 offen offset:2048 sc1
    buffer_load_dwordx4 v[172:175], v12, s[60:63], s98 offen offset:3072 sc1
    s_add_u32 s98, s98, 4096
    buffer_load_dwordx4 v[176:179], v12, s[60:63], s98 offen offset:0 sc1
    buffer_load_dwordx4 v[180:183], v12, s[60:63], s98 offen offset:1024 sc1
    buffer_load_dwordx4 v[184:187], v12, s[60:63], s98 offen offset:2048 sc1
    buffer_load_dwordx4 v[188:191], v12, s[60:63], s98 offen offset:3072 sc1
    s_add_u32 s98, s98, 4096
    s_waitcnt vmcnt(0)
    s_waitcnt lgkmcnt(0)
    s_barrier
    v_mov_b32 v80, 0
    v_mov_b32 v81, 0
    v_mov_b32 v82, 0
    v_mov_b32 v83, 0
    v_mov_b32 v84, 0
    v_mov_b32 v85, 0
    v_mov_b32 v86, 0
    v_mov_b32 v87, 0
    ds_read_b128 v[88:91], v4 offset:0
    ds_read_b128 v[92:95], v5 offset:0
    ds_read_b128 v[96:99], v6 offset:0
    ds_read_b128 v[100:103], v7 offset:0
    ds_read_b128 v[104:107], v4 offset:256
    ds_read_b128 v[108:111], v5 offset:256
    ds_read_b128 v[112:115], v6 offset:256
    ds_read_b128 v[116:119], v7 offset:256
    s_waitcnt lgkmcnt(7)
    v_mfma_f32_16x16x32_bf16 v[80:83], v[88:91], v[128:131], v[80:83]
    v_mfma_f32_16x16x32_bf16 v[84:87], v[88:91], v[132:135], v[84:87]
    s_waitcnt lgkmcnt(6)
    v_mfma_f32_16x16x32_bf16 v[80:83], v[92:95], v[136:139], v[80:83]
    v_mfma_f32_16x16x32_bf16 v[84:87], v[92:95], v[140:143], v[84:87]
    s_waitcnt lgkmcnt(5)
    v_mfma_f32_16x16x32_bf16 v[80:83], v[96:99], v[144:147], v[80:83]
    v_mfma_f32_16x16x32_bf16 v[84:87], v[96:99], v[148:151], v[84:87]
    s_waitcnt lgkmcnt(4)
    v_mfma_f32_16x16x32_bf16 v[80:83], v[100:103], v[152:155], v[80:83]
    v_mfma_f32_16x16x32_bf16 v[84:87], v[100:103], v[156:159], v[84:87]
    s_waitcnt lgkmcnt(3)
    v_mfma_f32_16x16x32_bf16 v[80:83], v[104:107], v[160:163], v[80:83]
    v_mfma_f32_16x16x32_bf16 v[84:87], v[104:107], v[164:167], v[84:87]
    s_waitcnt lgkmcnt(2)
    v_mfma_f32_16x16x32_bf16 v[80:83], v[108:111], v[168:171], v[80:83]
    v_mfma_f32_16x16x32_bf16 v[84:87], v[108:111], v[172:175], v[84:87]
    s_waitcnt lgkmcnt(1)
    v_mfma_f32_16x16x32_bf16 v[80:83], v[112:115], v[176:179], v[80:83]
    v_mfma_f32_16x16x32_bf16 v[84:87], v[112:115], v[180:183], v[84:87]
    s_waitcnt lgkmcnt(0)
    v_mfma_f32_16x16x32_bf16 v[80:83], v[116:119], v[184:187], v[80:83]
    v_mfma_f32_16x16x32_bf16 v[84:87], v[116:119], v[188:191], v[84:87]
    s_nop 7
    s_nop 1
    v_add_f32 v80, v80, v84
    v_add_f32 v81, v81, v85
    v_add_f32 v82, v82, v86
    v_add_f32 v83, v83, v87
    ds_write_b128 v28, v[80:83]
    s_waitcnt lgkmcnt(0)
    s_barrier
    ds_read_b128 v[88:91], v29 offset:0
    ds_read_b128 v[92:95], v29 offset:1024
    ds_read_b128 v[96:99], v29 offset:2048
    ds_read_b128 v[100:103], v29 offset:3072
    ds_read_b128 v[104:107], v29 offset:4096
    ds_read_b128 v[108:111], v29 offset:5120
    ds_read_b128 v[112:115], v29 offset:6144
    ds_read_b128 v[116:119], v29 offset:7168
    s_waitcnt lgkmcnt(0)
    v_add_f32 v88, v88, v92
    v_add_f32 v96, v96, v100
    v_add_f32 v88, v88, v96
    v_mul_f32 v80, s29, v88
    v_add_f32 v89, v89, v93
    v_add_f32 v97, v97, v101
    v_add_f32 v89, v89, v97
    v_mul_f32 v81, s29, v89
    v_add_f32 v90, v90, v94
    v_add_f32 v98, v98, v102
    v_add_f32 v90, v90, v98
    v_mul_f32 v82, s29, v90
    v_add_f32 v91, v91, v95
    v_add_f32 v99, v99, v103
    v_add_f32 v91, v91, v99
    v_mul_f32 v83, s29, v91
    v_add_f32 v104, v104, v108
    v_add_f32 v112, v112, v116
    v_add_f32 v104, v104, v112
    v_mul_f32 v84, s29, v104
    v_add_f32 v105, v105, v109
    v_add_f32 v113, v113, v117
    v_add_f32 v105, v105, v113
    v_mul_f32 v85, s29, v105
    v_add_f32 v106, v106, v110
    v_add_f32 v114, v114, v118
    v_add_f32 v106, v106, v114
    v_mul_f32 v86, s29, v106
    v_add_f32 v107, v107, v111
    v_add_f32 v115, v115, v119
    v_add_f32 v107, v107, v115
    v_mul_f32 v87, s29, v107
    v_max3_f32 v12, v80, v81, v82
    v_max3_f32 v12, v12, v83, v84
    v_max3_f32 v12, v12, v85, v86
    v_max3_f32 v12, v12, v87, v124
    v_mov_b32 v13, v12
    s_nop 1
    v_permlane16_swap_b32 v13, v12
    s_nop 1
    v_max_f32 v12, v12, v13
    v_mov_b32 v13, v12
    s_nop 1
    v_permlane32_swap_b32 v13, v12
    s_nop 1
    v_max_f32 v12, v12, v13
    v_sub_f32 v126, v124, v12
    v_exp_f32 v126, v126
    v_mov_b32 v124, v12
    v_sub_f32 v80, v80, v12
    v_sub_f32 v81, v81, v12
    v_sub_f32 v82, v82, v12
    v_sub_f32 v83, v83, v12
    v_sub_f32 v84, v84, v12
    v_sub_f32 v85, v85, v12
    v_sub_f32 v86, v86, v12
    v_sub_f32 v87, v87, v12
    v_exp_f32 v80, v80
    v_exp_f32 v81, v81
    v_exp_f32 v82, v82
    v_exp_f32 v83, v83
    v_exp_f32 v84, v84
    v_exp_f32 v85, v85
    v_exp_f32 v86, v86
    v_exp_f32 v87, v87
    v_mul_f32 v125, v125, v126
    v_add_f32 v125, v125, v80
    v_add_f32 v125, v125, v81
    v_add_f32 v125, v125, v82
    v_add_f32 v125, v125, v83
    v_add_f32 v125, v125, v84
    v_add_f32 v125, v125, v85
    v_add_f32 v125, v125, v86
    v_add_f32 v125, v125, v87
    v_cvt_pk_bf16_f32 v120, v80, v81
    v_cvt_pk_bf16_f32 v121, v82, v83
    v_cvt_pk_bf16_f32 v122, v84, v85
    v_cvt_pk_bf16_f32 v123, v86, v87
    ds_read_b64_tr_b16 v[88:89], v16
    ds_read_b64_tr_b16 v[90:91], v16 offset:32768
    ds_read_b64_tr_b16 v[92:93], v17
    ds_read_b64_tr_b16 v[94:95], v17 offset:32768
    ds_read_b64_tr_b16 v[96:97], v18
    ds_read_b64_tr_b16 v[98:99], v18 offset:32768
    ds_read_b64_tr_b16 v[100:101], v19
    ds_read_b64_tr_b16 v[102:103], v19 offset:32768
    ds_read_b64_tr_b16 v[104:105], v20
    ds_read_b64_tr_b16 v[106:107], v20 offset:32768
    ds_read_b64_tr_b16 v[108:109], v21
    ds_read_b64_tr_b16 v[110:111], v21 offset:32768
    ds_read_b64_tr_b16 v[112:113], v22
    ds_read_b64_tr_b16 v[114:115], v22 offset:32768
    ds_read_b64_tr_b16 v[116:117], v23
    ds_read_b64_tr_b16 v[118:119], v23 offset:32768
    v_mul_f32 v32, v32, v126
    v_mul_f32 v33, v33, v126
    v_mul_f32 v34, v34, v126
    v_mul_f32 v35, v35, v126
    v_mul_f32 v36, v36, v126
    v_mul_f32 v37, v37, v126
    v_mul_f32 v38, v38, v126
    v_mul_f32 v39, v39, v126
    v_mul_f32 v40, v40, v126
    v_mul_f32 v41, v41, v126
    v_mul_f32 v42, v42, v126
    v_mul_f32 v43, v43, v126
    v_mul_f32 v44, v44, v126
    v_mul_f32 v45, v45, v126
    v_mul_f32 v46, v46, v126
    v_mul_f32 v47, v47, v126
    v_mul_f32 v48, v48, v126
    v_mul_f32 v49, v49, v126
    v_mul_f32 v50, v50, v126
    v_mul_f32 v51, v51, v126
    v_mul_f32 v52, v52, v126
    v_mul_f32 v53, v53, v126
    v_mul_f32 v54, v54, v126
    v_mul_f32 v55, v55, v126
    v_mul_f32 v56, v56, v126
    v_mul_f32 v57, v57, v126
    v_mul_f32 v58, v58, v126
    v_mul_f32 v59, v59, v126
    v_mul_f32 v60, v60, v126
    v_mul_f32 v61, v61, v126
    v_mul_f32 v62, v62, v126
    v_mul_f32 v63, v63, v126
    s_waitcnt lgkmcnt(14)
    v_mfma_f32_16x16x32_bf16 v[32:35], v[88:91], v[120:123], v[32:35]
    s_waitcnt lgkmcnt(12)
    v_mfma_f32_16x16x32_bf16 v[36:39], v[92:95], v[120:123], v[36:39]
    s_waitcnt lgkmcnt(10)
    v_mfma_f32_16x16x32_bf16 v[40:43], v[96:99], v[120:123], v[40:43]
    s_waitcnt lgkmcnt(8)
    v_mfma_f32_16x16x32_bf16 v[44:47], v[100:103], v[120:123], v[44:47]
    s_waitcnt lgkmcnt(6)
    v_mfma_f32_16x16x32_bf16 v[48:51], v[104:107], v[120:123], v[48:51]
    s_waitcnt lgkmcnt(4)
    v_mfma_f32_16x16x32_bf16 v[52:55], v[108:111], v[120:123], v[52:55]
    s_waitcnt lgkmcnt(2)
    v_mfma_f32_16x16x32_bf16 v[56:59], v[112:115], v[120:123], v[56:59]
    s_waitcnt lgkmcnt(0)
    v_mfma_f32_16x16x32_bf16 v[60:63], v[116:119], v[120:123], v[60:63]
    s_waitcnt lgkmcnt(0)
    s_barrier
    ds_write_b128 v31, v[192:195] offset:0
    ds_write_b128 v31, v[196:199] offset:1024
    ds_write_b128 v31, v[200:203] offset:2048
    ds_write_b128 v31, v[204:207] offset:3072
    ds_write_b128 v31, v[208:211] offset:4096
    ds_write_b128 v31, v[212:215] offset:5120
    ds_write_b128 v31, v[216:219] offset:6144
    ds_write_b128 v31, v[220:223] offset:7168
    v_add_u32 v4, 0x10000, v4
    v_add_u32 v5, 0x10000, v5
    v_add_u32 v6, 0x10000, v6
    v_add_u32 v7, 0x10000, v7
    v_add_u32 v16, 0x10000, v16
    v_add_u32 v17, 0x10000, v17
    v_add_u32 v18, 0x10000, v18
    v_add_u32 v19, 0x10000, v19
    v_add_u32 v20, 0x10000, v20
    v_add_u32 v21, 0x10000, v21
    v_add_u32 v22, 0x10000, v22
    v_add_u32 v23, 0x10000, v23
    v_mov_b32 v80, 0
    v_mov_b32 v81, 0
    v_mov_b32 v82, 0
    v_mov_b32 v83, 0
    v_mov_b32 v84, 0
    v_mov_b32 v85, 0
    v_mov_b32 v86, 0
    v_mov_b32 v87, 0
    ds_read_b128 v[88:91], v4 offset:0
    ds_read_b128 v[92:95], v5 offset:0
    ds_read_b128 v[96:99], v6 offset:0
    ds_read_b128 v[100:103], v7 offset:0
    ds_read_b128 v[104:107], v4 offset:256
    ds_read_b128 v[108:111], v5 offset:256
    ds_read_b128 v[112:115], v6 offset:256
    ds_read_b128 v[116:119], v7 offset:256
    s_waitcnt lgkmcnt(7)
    v_mfma_f32_16x16x32_bf16 v[80:83], v[88:91], v[128:131], v[80:83]
    v_mfma_f32_16x16x32_bf16 v[84:87], v[88:91], v[132:135], v[84:87]
    s_waitcnt lgkmcnt(6)
    v_mfma_f32_16x16x32_bf16 v[80:83], v[92:95], v[136:139], v[80:83]
    v_mfma_f32_16x16x32_bf16 v[84:87], v[92:95], v[140:143], v[84:87]
    s_waitcnt lgkmcnt(5)
    v_mfma_f32_16x16x32_bf16 v[80:83], v[96:99], v[144:147], v[80:83]
    v_mfma_f32_16x16x32_bf16 v[84:87], v[96:99], v[148:151], v[84:87]
    s_waitcnt lgkmcnt(4)
    v_mfma_f32_16x16x32_bf16 v[80:83], v[100:103], v[152:155], v[80:83]
    v_mfma_f32_16x16x32_bf16 v[84:87], v[100:103], v[156:159], v[84:87]
    s_waitcnt lgkmcnt(3)
    v_mfma_f32_16x16x32_bf16 v[80:83], v[104:107], v[160:163], v[80:83]
    v_mfma_f32_16x16x32_bf16 v[84:87], v[104:107], v[164:167], v[84:87]
    s_waitcnt lgkmcnt(2)
    v_mfma_f32_16x16x32_bf16 v[80:83], v[108:111], v[168:171], v[80:83]
    v_mfma_f32_16x16x32_bf16 v[84:87], v[108:111], v[172:175], v[84:87]
    s_waitcnt lgkmcnt(1)
    v_mfma_f32_16x16x32_bf16 v[80:83], v[112:115], v[176:179], v[80:83]
    v_mfma_f32_16x16x32_bf16 v[84:87], v[112:115], v[180:183], v[84:87]
    s_waitcnt lgkmcnt(0)
    v_mfma_f32_16x16x32_bf16 v[80:83], v[116:119], v[184:187], v[80:83]
    v_mfma_f32_16x16x32_bf16 v[84:87], v[116:119], v[188:191], v[84:87]
    s_nop 7
    s_nop 1
    v_add_f32 v80, v80, v84
    v_add_f32 v81, v81, v85
    v_add_f32 v82, v82, v86
    v_add_f32 v83, v83, v87
    ds_write_b128 v28, v[80:83]
    s_waitcnt lgkmcnt(0)
    s_barrier
    ds_read_b128 v[88:91], v29 offset:0
    ds_read_b128 v[92:95], v29 offset:1024
    ds_read_b128 v[96:99], v29 offset:2048
    ds_read_b128 v[100:103], v29 offset:3072
    ds_read_b128 v[104:107], v29 offset:4096
    ds_read_b128 v[108:111], v29 offset:5120
    ds_read_b128 v[112:115], v29 offset:6144
    ds_read_b128 v[116:119], v29 offset:7168
    s_waitcnt lgkmcnt(0)
    v_add_f32 v88, v88, v92
    v_add_f32 v96, v96, v100
    v_add_f32 v88, v88, v96
    v_mul_f32 v80, s29, v88
    v_add_f32 v89, v89, v93
    v_add_f32 v97, v97, v101
    v_add_f32 v89, v89, v97
    v_mul_f32 v81, s29, v89
    v_add_f32 v90, v90, v94
    v_add_f32 v98, v98, v102
    v_add_f32 v90, v90, v98
    v_mul_f32 v82, s29, v90
    v_add_f32 v91, v91, v95
    v_add_f32 v99, v99, v103
    v_add_f32 v91, v91, v99
    v_mul_f32 v83, s29, v91
    v_add_f32 v104, v104, v108
    v_add_f32 v112, v112, v116
    v_add_f32 v104, v104, v112
    v_mul_f32 v84, s29, v104
    v_add_f32 v105, v105, v109
    v_add_f32 v113, v113, v117
    v_add_f32 v105, v105, v113
    v_mul_f32 v85, s29, v105
    v_add_f32 v106, v106, v110
    v_add_f32 v114, v114, v118
    v_add_f32 v106, v106, v114
    v_mul_f32 v86, s29, v106
    v_add_f32 v107, v107, v111
    v_add_f32 v115, v115, v119
    v_add_f32 v107, v107, v115
    v_mul_f32 v87, s29, v107
    v_max3_f32 v12, v80, v81, v82
    v_max3_f32 v12, v12, v83, v84
    v_max3_f32 v12, v12, v85, v86
    v_max3_f32 v12, v12, v87, v124
    v_mov_b32 v13, v12
    s_nop 1
    v_permlane16_swap_b32 v13, v12
    s_nop 1
    v_max_f32 v12, v12, v13
    v_mov_b32 v13, v12
    s_nop 1
    v_permlane32_swap_b32 v13, v12
    s_nop 1
    v_max_f32 v12, v12, v13
    v_sub_f32 v126, v124, v12
    v_exp_f32 v126, v126
    v_mov_b32 v124, v12
    v_sub_f32 v80, v80, v12
    v_sub_f32 v81, v81, v12
    v_sub_f32 v82, v82, v12
    v_sub_f32 v83, v83, v12
    v_sub_f32 v84, v84, v12
    v_sub_f32 v85, v85, v12
    v_sub_f32 v86, v86, v12
    v_sub_f32 v87, v87, v12
    v_exp_f32 v80, v80
    v_exp_f32 v81, v81
    v_exp_f32 v82, v82
    v_exp_f32 v83, v83
    v_exp_f32 v84, v84
    v_exp_f32 v85, v85
    v_exp_f32 v86, v86
    v_exp_f32 v87, v87
    v_mul_f32 v125, v125, v126
    v_add_f32 v125, v125, v80
    v_add_f32 v125, v125, v81
    v_add_f32 v125, v125, v82
    v_add_f32 v125, v125, v83
    v_add_f32 v125, v125, v84
    v_add_f32 v125, v125, v85
    v_add_f32 v125, v125, v86
    v_add_f32 v125, v125, v87
    v_cvt_pk_bf16_f32 v120, v80, v81
    v_cvt_pk_bf16_f32 v121, v82, v83
    v_cvt_pk_bf16_f32 v122, v84, v85
    v_cvt_pk_bf16_f32 v123, v86, v87
    ds_read_b64_tr_b16 v[88:89], v16
    ds_read_b64_tr_b16 v[90:91], v16 offset:32768
    ds_read_b64_tr_b16 v[92:93], v17
    ds_read_b64_tr_b16 v[94:95], v17 offset:32768
    ds_read_b64_tr_b16 v[96:97], v18
    ds_read_b64_tr_b16 v[98:99], v18 offset:32768
    ds_read_b64_tr_b16 v[100:101], v19
    ds_read_b64_tr_b16 v[102:103], v19 offset:32768
    ds_read_b64_tr_b16 v[104:105], v20
    ds_read_b64_tr_b16 v[106:107], v20 offset:32768
    ds_read_b64_tr_b16 v[108:109], v21
    ds_read_b64_tr_b16 v[110:111], v21 offset:32768
    ds_read_b64_tr_b16 v[112:113], v22
    ds_read_b64_tr_b16 v[114:115], v22 offset:32768
    ds_read_b64_tr_b16 v[116:117], v23
    ds_read_b64_tr_b16 v[118:119], v23 offset:32768
    v_mul_f32 v32, v32, v126
    v_mul_f32 v33, v33, v126
    v_mul_f32 v34, v34, v126
    v_mul_f32 v35, v35, v126
    v_mul_f32 v36, v36, v126
    v_mul_f32 v37, v37, v126
    v_mul_f32 v38, v38, v126
    v_mul_f32 v39, v39, v126
    v_mul_f32 v40, v40, v126
    v_mul_f32 v41, v41, v126
    v_mul_f32 v42, v42, v126
    v_mul_f32 v43, v43, v126
    v_mul_f32 v44, v44, v126
    v_mul_f32 v45, v45, v126
    v_mul_f32 v46, v46, v126
    v_mul_f32 v47, v47, v126
    v_mul_f32 v48, v48, v126
    v_mul_f32 v49, v49, v126
    v_mul_f32 v50, v50, v126
    v_mul_f32 v51, v51, v126
    v_mul_f32 v52, v52, v126
    v_mul_f32 v53, v53, v126
    v_mul_f32 v54, v54, v126
    v_mul_f32 v55, v55, v126
    v_mul_f32 v56, v56, v126
    v_mul_f32 v57, v57, v126
    v_mul_f32 v58, v58, v126
    v_mul_f32 v59, v59, v126
    v_mul_f32 v60, v60, v126
    v_mul_f32 v61, v61, v126
    v_mul_f32 v62, v62, v126
    v_mul_f32 v63, v63, v126
    s_waitcnt lgkmcnt(14)
    v_mfma_f32_16x16x32_bf16 v[32:35], v[88:91], v[120:123], v[32:35]
    s_waitcnt lgkmcnt(12)
    v_mfma_f32_16x16x32_bf16 v[36:39], v[92:95], v[120:123], v[36:39]
    s_waitcnt lgkmcnt(10)
    v_mfma_f32_16x16x32_bf16 v[40:43], v[96:99], v[120:123], v[40:43]
    s_waitcnt lgkmcnt(8)
    v_mfma_f32_16x16x32_bf16 v[44:47], v[100:103], v[120:123], v[44:47]
    s_waitcnt lgkmcnt(6)
    v_mfma_f32_16x16x32_bf16 v[48:51], v[104:107], v[120:123], v[48:51]
    s_waitcnt lgkmcnt(4)
    v_mfma_f32_16x16x32_bf16 v[52:55], v[108:111], v[120:123], v[52:55]
    s_waitcnt lgkmcnt(2)
    v_mfma_f32_16x16x32_bf16 v[56:59], v[112:115], v[120:123], v[56:59]
    s_waitcnt lgkmcnt(0)
    v_mfma_f32_16x16x32_bf16 v[60:63], v[116:119], v[120:123], v[60:63]
    s_waitcnt lgkmcnt(0)
    s_barrier
    v_add_u32 v31, 0x10000, v31
    ds_write_b128 v31, v[224:227] offset:0
    ds_write_b128 v31, v[228:231] offset:1024
    ds_write_b128 v31, v[232:235] offset:2048
    ds_write_b128 v31, v[236:239] offset:3072
    ds_write_b128 v31, v[240:243] offset:4096
    ds_write_b128 v31, v[244:247] offset:5120
    ds_write_b128 v31, v[248:251] offset:6144
    ds_write_b128 v31, v[252:255] offset:7168
    v_subrev_u32 v4, 0x10000, v4
    v_subrev_u32 v5, 0x10000, v5
    v_subrev_u32 v6, 0x10000, v6
    v_subrev_u32 v7, 0x10000, v7
    v_subrev_u32 v16, 0x10000, v16
    v_subrev_u32 v17, 0x10000, v17
    v_subrev_u32 v18, 0x10000, v18
    v_subrev_u32 v19, 0x10000, v19
    v_subrev_u32 v20, 0x10000, v20
    v_subrev_u32 v21, 0x10000, v21
    v_subrev_u32 v22, 0x10000, v22
    v_subrev_u32 v23, 0x10000, v23
    buffer_load_dwordx4 v[192:195], v30, s[52:55], s34 offen nt
    s_add_u32 s34, s34, 8192
    buffer_load_dwordx4 v[196:199], v30, s[52:55], s34 offen nt
    s_add_u32 s34, s34, 8192
    v_mov_b32 v80, 0
    v_mov_b32 v81, 0
    v_mov_b32 v82, 0
    v_mov_b32 v83, 0
    v_mov_b32 v84, 0
    v_mov_b32 v85, 0
    v_mov_b32 v86, 0
    v_mov_b32 v87, 0
    ds_read_b128 v[88:91], v4 offset:0
    ds_read_b128 v[92:95], v5 offset:0
    ds_read_b128 v[96:99], v6 offset:0
    ds_read_b128 v[100:103], v7 offset:0
    ds_read_b128 v[104:107], v4 offset:256
    ds_read_b128 v[108:111], v5 offset:256
    ds_read_b128 v[112:115], v6 offset:256
    ds_read_b128 v[116:119], v7 offset:256
    s_waitcnt lgkmcnt(7)
    v_mfma_f32_16x16x32_bf16 v[80:83], v[88:91], v[128:131], v[80:83]
    v_mfma_f32_16x16x32_bf16 v[84:87], v[88:91], v[132:135], v[84:87]
    s_waitcnt lgkmcnt(6)
    v_mfma_f32_16x16x32_bf16 v[80:83], v[92:95], v[136:139], v[80:83]
    v_mfma_f32_16x16x32_bf16 v[84:87], v[92:95], v[140:143], v[84:87]
    s_waitcnt lgkmcnt(5)
    v_mfma_f32_16x16x32_bf16 v[80:83], v[96:99], v[144:147], v[80:83]
    v_mfma_f32_16x16x32_bf16 v[84:87], v[96:99], v[148:151], v[84:87]
    s_waitcnt lgkmcnt(4)
    v_mfma_f32_16x16x32_bf16 v[80:83], v[100:103], v[152:155], v[80:83]
    v_mfma_f32_16x16x32_bf16 v[84:87], v[100:103], v[156:159], v[84:87]
    s_waitcnt lgkmcnt(3)
    v_mfma_f32_16x16x32_bf16 v[80:83], v[104:107], v[160:163], v[80:83]
    v_mfma_f32_16x16x32_bf16 v[84:87], v[104:107], v[164:167], v[84:87]
    s_waitcnt lgkmcnt(2)
    v_mfma_f32_16x16x32_bf16 v[80:83], v[108:111], v[168:171], v[80:83]
    v_mfma_f32_16x16x32_bf16 v[84:87], v[108:111], v[172:175], v[84:87]
    s_waitcnt lgkmcnt(1)
    v_mfma_f32_16x16x32_bf16 v[80:83], v[112:115], v[176:179], v[80:83]
    v_mfma_f32_16x16x32_bf16 v[84:87], v[112:115], v[180:183], v[84:87]
    s_waitcnt lgkmcnt(0)
    v_mfma_f32_16x16x32_bf16 v[80:83], v[116:119], v[184:187], v[80:83]
    v_mfma_f32_16x16x32_bf16 v[84:87], v[116:119], v[188:191], v[84:87]
    s_nop 7
    s_nop 1
    v_add_f32 v80, v80, v84
    v_add_f32 v81, v81, v85
    v_add_f32 v82, v82, v86
    v_add_f32 v83, v83, v87
    ds_write_b128 v28, v[80:83]
    buffer_load_dwordx4 v[200:203], v30, s[52:55], s34 offen nt
    s_add_u32 s34, s34, 8192
    buffer_load_dwordx4 v[204:207], v30, s[52:55], s34 offen nt
    s_add_u32 s34, s34, 8192
    s_waitcnt lgkmcnt(0)
    s_barrier
    ds_read_b128 v[88:91], v29 offset:0
    ds_read_b128 v[92:95], v29 offset:1024
    ds_read_b128 v[96:99], v29 offset:2048
    ds_read_b128 v[100:103], v29 offset:3072
    ds_read_b128 v[104:107], v29 offset:4096
    ds_read_b128 v[108:111], v29 offset:5120
    ds_read_b128 v[112:115], v29 offset:6144
    ds_read_b128 v[116:119], v29 offset:7168
    s_waitcnt lgkmcnt(0)
    v_add_f32 v88, v88, v92
    v_add_f32 v96, v96, v100
    v_add_f32 v88, v88, v96
    v_mul_f32 v80, s29, v88
    v_add_f32 v89, v89, v93
    v_add_f32 v97, v97, v101
    v_add_f32 v89, v89, v97
    v_mul_f32 v81, s29, v89
    v_add_f32 v90, v90, v94
    v_add_f32 v98, v98, v102
    v_add_f32 v90, v90, v98
    v_mul_f32 v82, s29, v90
    v_add_f32 v91, v91, v95
    v_add_f32 v99, v99, v103
    v_add_f32 v91, v91, v99
    v_mul_f32 v83, s29, v91
    v_add_f32 v104, v104, v108
    v_add_f32 v112, v112, v116
    v_add_f32 v104, v104, v112
    v_mul_f32 v84, s29, v104
    v_add_f32 v105, v105, v109
    v_add_f32 v113, v113, v117
    v_add_f32 v105, v105, v113
    v_mul_f32 v85, s29, v105
    v_add_f32 v106, v106, v110
    v_add_f32 v114, v114, v118
    v_add_f32 v106, v106, v114
    v_mul_f32 v86, s29, v106
    v_add_f32 v107, v107, v111
    v_add_f32 v115, v115, v119
    v_add_f32 v107, v107, v115
    v_mul_f32 v87, s29, v107
    buffer_load_dwordx4 v[208:211], v30, s[52:55], s34 offen nt
    s_add_u32 s34, s34, 8192
    buffer_load_dwordx4 v[212:215], v30, s[52:55], s34 offen nt
    s_add_u32 s34, s34, 8192
    v_max3_f32 v12, v80, v81, v82
    v_max3_f32 v12, v12, v83, v84
    v_max3_f32 v12, v12, v85, v86
    v_max3_f32 v12, v12, v87, v124
    v_mov_b32 v13, v12
    s_nop 1
    v_permlane16_swap_b32 v13, v12
    s_nop 1
    v_max_f32 v12, v12, v13
    v_mov_b32 v13, v12
    s_nop 1
    v_permlane32_swap_b32 v13, v12
    s_nop 1
    v_max_f32 v12, v12, v13
    v_sub_f32 v126, v124, v12
    v_exp_f32 v126, v126
    v_mov_b32 v124, v12
    v_sub_f32 v80, v80, v12
    v_sub_f32 v81, v81, v12
    v_sub_f32 v82, v82, v12
    v_sub_f32 v83, v83, v12
    v_sub_f32 v84, v84, v12
    v_sub_f32 v85, v85, v12
    v_sub_f32 v86, v86, v12
    v_sub_f32 v87, v87, v12
    v_exp_f32 v80, v80
    v_exp_f32 v81, v81
    v_exp_f32 v82, v82
    v_exp_f32 v83, v83
    v_exp_f32 v84, v84
    v_exp_f32 v85, v85
    v_exp_f32 v86, v86
    v_exp_f32 v87, v87
    v_mul_f32 v125, v125, v126
    v_add_f32 v125, v125, v80
    v_add_f32 v125, v125, v81
    v_add_f32 v125, v125, v82
    v_add_f32 v125, v125, v83
    v_add_f32 v125, v125, v84
    v_add_f32 v125, v125, v85
    v_add_f32 v125, v125, v86
    v_add_f32 v125, v125, v87
    v_cvt_pk_bf16_f32 v120, v80, v81
    v_cvt_pk_bf16_f32 v121, v82, v83
    v_cvt_pk_bf16_f32 v122, v84, v85
    v_cvt_pk_bf16_f32 v123, v86, v87
    ds_read_b64_tr_b16 v[88:89], v16
    ds_read_b64_tr_b16 v[90:91], v16 offset:32768
    ds_read_b64_tr_b16 v[92:93], v17
    ds_read_b64_tr_b16 v[94:95], v17 offset:32768
    ds_read_b64_tr_b16 v[96:97], v18
    ds_read_b64_tr_b16 v[98:99], v18 offset:32768
    ds_read_b64_tr_b16 v[100:101], v19
    ds_read_b64_tr_b16 v[102:103], v19 offset:32768
    ds_read_b64_tr_b16 v[104:105], v20
    ds_read_b64_tr_b16 v[106:107], v20 offset:32768
    ds_read_b64_tr_b16 v[108:109], v21
    ds_read_b64_tr_b16 v[110:111], v21 offset:32768
    ds_read_b64_tr_b16 v[112:113], v22
    ds_read_b64_tr_b16 v[114:115], v22 offset:32768
    ds_read_b64_tr_b16 v[116:117], v23
    ds_read_b64_tr_b16 v[118:119], v23 offset:32768
    buffer_load_dwordx4 v[216:219], v30, s[52:55], s34 offen nt
    s_add_u32 s34, s34, 8192
    buffer_load_dwordx4 v[220:223], v30, s[52:55], s34 offen nt
    s_add_u32 s34, s34, 8192
    v_mul_f32 v32, v32, v126
    v_mul_f32 v33, v33, v126
    v_mul_f32 v34, v34, v126
    v_mul_f32 v35, v35, v126
    v_mul_f32 v36, v36, v126
    v_mul_f32 v37, v37, v126
    v_mul_f32 v38, v38, v126
    v_mul_f32 v39, v39, v126
    v_mul_f32 v40, v40, v126
    v_mul_f32 v41, v41, v126
    v_mul_f32 v42, v42, v126
    v_mul_f32 v43, v43, v126
    v_mul_f32 v44, v44, v126
    v_mul_f32 v45, v45, v126
    v_mul_f32 v46, v46, v126
    v_mul_f32 v47, v47, v126
    v_mul_f32 v48, v48, v126
    v_mul_f32 v49, v49, v126
    v_mul_f32 v50, v50, v126
    v_mul_f32 v51, v51, v126
    v_mul_f32 v52, v52, v126
    v_mul_f32 v53, v53, v126
    v_mul_f32 v54, v54, v126
    v_mul_f32 v55, v55, v126
    v_mul_f32 v56, v56, v126
    v_mul_f32 v57, v57, v126
    v_mul_f32 v58, v58, v126
    v_mul_f32 v59, v59, v126
    v_mul_f32 v60, v60, v126
    v_mul_f32 v61, v61, v126
    v_mul_f32 v62, v62, v126
    v_mul_f32 v63, v63, v126
    s_waitcnt lgkmcnt(14)
    v_mfma_f32_16x16x32_bf16 v[32:35], v[88:91], v[120:123], v[32:35]
    s_waitcnt lgkmcnt(12)
    v_mfma_f32_16x16x32_bf16 v[36:39], v[92:95], v[120:123], v[36:39]
    s_waitcnt lgkmcnt(10)
    v_mfma_f32_16x16x32_bf16 v[40:43], v[96:99], v[120:123], v[40:43]
    s_waitcnt lgkmcnt(8)
    v_mfma_f32_16x16x32_bf16 v[44:47], v[100:103], v[120:123], v[44:47]
    s_waitcnt lgkmcnt(6)
    v_mfma_f32_16x16x32_bf16 v[48:51], v[104:107], v[120:123], v[48:51]
    s_waitcnt lgkmcnt(4)
    v_mfma_f32_16x16x32_bf16 v[52:55], v[108:111], v[120:123], v[52:55]
    s_waitcnt lgkmcnt(2)
    v_mfma_f32_16x16x32_bf16 v[56:59], v[112:115], v[120:123], v[56:59]
    s_waitcnt lgkmcnt(0)
    v_mfma_f32_16x16x32_bf16 v[60:63], v[116:119], v[120:123], v[60:63]
    s_waitcnt lgkmcnt(0)
    s_barrier
    v_add_u32 v4, 0x10000, v4
    v_add_u32 v5, 0x10000, v5
    v_add_u32 v6, 0x10000, v6
    v_add_u32 v7, 0x10000, v7
    v_add_u32 v16, 0x10000, v16
    v_add_u32 v17, 0x10000, v17
    v_add_u32 v18, 0x10000, v18
    v_add_u32 v19, 0x10000, v19
    v_add_u32 v20, 0x10000, v20
    v_add_u32 v21, 0x10000, v21
    v_add_u32 v22, 0x10000, v22
    v_add_u32 v23, 0x10000, v23
    buffer_load_dwordx4 v[224:227], v30, s[52:55], s34 offen nt
    s_add_u32 s34, s34, 8192
    buffer_load_dwordx4 v[228:231], v30, s[52:55], s34 offen nt
    s_add_u32 s34, s34, 8192
    v_mov_b32 v80, 0
    v_mov_b32 v81, 0
    v_mov_b32 v82, 0
    v_mov_b32 v83, 0
    v_mov_b32 v84, 0
    v_mov_b32 v85, 0
    v_mov_b32 v86, 0
    v_mov_b32 v87, 0
    ds_read_b128 v[88:91], v4 offset:0
    ds_read_b128 v[92:95], v5 offset:0
    ds_read_b128 v[96:99], v6 offset:0
    ds_read_b128 v[100:103], v7 offset:0
    ds_read_b128 v[104:107], v4 offset:256
    ds_read_b128 v[108:111], v5 offset:256
    ds_read_b128 v[112:115], v6 offset:256
    ds_read_b128 v[116:119], v7 offset:256
    s_waitcnt lgkmcnt(7)
    v_mfma_f32_16x16x32_bf16 v[80:83], v[88:91], v[128:131], v[80:83]
    v_mfma_f32_16x16x32_bf16 v[84:87], v[88:91], v[132:135], v[84:87]
    s_waitcnt lgkmcnt(6)
    v_mfma_f32_16x16x32_bf16 v[80:83], v[92:95], v[136:139], v[80:83]
    v_mfma_f32_16x16x32_bf16 v[84:87], v[92:95], v[140:143], v[84:87]
    s_waitcnt lgkmcnt(5)
    v_mfma_f32_16x16x32_bf16 v[80:83], v[96:99], v[144:147], v[80:83]
    v_mfma_f32_16x16x32_bf16 v[84:87], v[96:99], v[148:151], v[84:87]
    s_waitcnt lgkmcnt(4)
    v_mfma_f32_16x16x32_bf16 v[80:83], v[100:103], v[152:155], v[80:83]
    v_mfma_f32_16x16x32_bf16 v[84:87], v[100:103], v[156:159], v[84:87]
    s_waitcnt lgkmcnt(3)
    v_mfma_f32_16x16x32_bf16 v[80:83], v[104:107], v[160:163], v[80:83]
    v_mfma_f32_16x16x32_bf16 v[84:87], v[104:107], v[164:167], v[84:87]
    s_waitcnt lgkmcnt(2)
    v_mfma_f32_16x16x32_bf16 v[80:83], v[108:111], v[168:171], v[80:83]
    v_mfma_f32_16x16x32_bf16 v[84:87], v[108:111], v[172:175], v[84:87]
    s_waitcnt lgkmcnt(1)
    v_mfma_f32_16x16x32_bf16 v[80:83], v[112:115], v[176:179], v[80:83]
    v_mfma_f32_16x16x32_bf16 v[84:87], v[112:115], v[180:183], v[84:87]
    s_waitcnt lgkmcnt(0)
    v_mfma_f32_16x16x32_bf16 v[80:83], v[116:119], v[184:187], v[80:83]
    v_mfma_f32_16x16x32_bf16 v[84:87], v[116:119], v[188:191], v[84:87]
    s_nop 7
    s_nop 1
    v_add_f32 v80, v80, v84
    v_add_f32 v81, v81, v85
    v_add_f32 v82, v82, v86
    v_add_f32 v83, v83, v87
    ds_write_b128 v28, v[80:83]
    buffer_load_dwordx4 v[232:235], v30, s[52:55], s34 offen nt
    s_add_u32 s34, s34, 8192
    buffer_load_dwordx4 v[236:239], v30, s[52:55], s34 offen nt
    s_add_u32 s34, s34, 8192
    s_waitcnt lgkmcnt(0)
    s_barrier
    ds_read_b128 v[88:91], v29 offset:0
    ds_read_b128 v[92:95], v29 offset:1024
    ds_read_b128 v[96:99], v29 offset:2048
    ds_read_b128 v[100:103], v29 offset:3072
    ds_read_b128 v[104:107], v29 offset:4096
    ds_read_b128 v[108:111], v29 offset:5120
    ds_read_b128 v[112:115], v29 offset:6144
    ds_read_b128 v[116:119], v29 offset:7168
    s_waitcnt lgkmcnt(0)
    v_add_f32 v88, v88, v92
    v_add_f32 v96, v96, v100
    v_add_f32 v88, v88, v96
    v_mul_f32 v80, s29, v88
    v_add_f32 v89, v89, v93
    v_add_f32 v97, v97, v101
    v_add_f32 v89, v89, v97
    v_mul_f32 v81, s29, v89
    v_add_f32 v90, v90, v94
    v_add_f32 v98, v98, v102
    v_add_f32 v90, v90, v98
    v_mul_f32 v82, s29, v90
    v_add_f32 v91, v91, v95
    v_add_f32 v99, v99, v103
    v_add_f32 v91, v91, v99
    v_mul_f32 v83, s29, v91
    v_add_f32 v104, v104, v108
    v_add_f32 v112, v112, v116
    v_add_f32 v104, v104, v112
    v_mul_f32 v84, s29, v104
    v_add_f32 v105, v105, v109
    v_add_f32 v113, v113, v117
    v_add_f32 v105, v105, v113
    v_mul_f32 v85, s29, v105
    v_add_f32 v106, v106, v110
    v_add_f32 v114, v114, v118
    v_add_f32 v106, v106, v114
    v_mul_f32 v86, s29, v106
    v_add_f32 v107, v107, v111
    v_add_f32 v115, v115, v119
    v_add_f32 v107, v107, v115
    v_mul_f32 v87, s29, v107
    buffer_load_dwordx4 v[240:243], v30, s[52:55], s34 offen nt
    s_add_u32 s34, s34, 8192
    buffer_load_dwordx4 v[244:247], v30, s[52:55], s34 offen nt
    s_add_u32 s34, s34, 8192
    v_max3_f32 v12, v80, v81, v82
    v_max3_f32 v12, v12, v83, v84
    v_max3_f32 v12, v12, v85, v86
    v_max3_f32 v12, v12, v87, v124
    v_mov_b32 v13, v12
    s_nop 1
    v_permlane16_swap_b32 v13, v12
    s_nop 1
    v_max_f32 v12, v12, v13
    v_mov_b32 v13, v12
    s_nop 1
    v_permlane32_swap_b32 v13, v12
    s_nop 1
    v_max_f32 v12, v12, v13
    v_sub_f32 v126, v124, v12
    v_exp_f32 v126, v126
    v_mov_b32 v124, v12
    v_sub_f32 v80, v80, v12
    v_sub_f32 v81, v81, v12
    v_sub_f32 v82, v82, v12
    v_sub_f32 v83, v83, v12
    v_sub_f32 v84, v84, v12
    v_sub_f32 v85, v85, v12
    v_sub_f32 v86, v86, v12
    v_sub_f32 v87, v87, v12
    v_exp_f32 v80, v80
    v_exp_f32 v81, v81
    v_exp_f32 v82, v82
    v_exp_f32 v83, v83
    v_exp_f32 v84, v84
    v_exp_f32 v85, v85
    v_exp_f32 v86, v86
    v_exp_f32 v87, v87
    v_mul_f32 v125, v125, v126
    v_add_f32 v125, v125, v80
    v_add_f32 v125, v125, v81
    v_add_f32 v125, v125, v82
    v_add_f32 v125, v125, v83
    v_add_f32 v125, v125, v84
    v_add_f32 v125, v125, v85
    v_add_f32 v125, v125, v86
    v_add_f32 v125, v125, v87
    v_cvt_pk_bf16_f32 v120, v80, v81
    v_cvt_pk_bf16_f32 v121, v82, v83
    v_cvt_pk_bf16_f32 v122, v84, v85
    v_cvt_pk_bf16_f32 v123, v86, v87
    ds_read_b64_tr_b16 v[88:89], v16
    ds_read_b64_tr_b16 v[90:91], v16 offset:32768
    ds_read_b64_tr_b16 v[92:93], v17
    ds_read_b64_tr_b16 v[94:95], v17 offset:32768
    ds_read_b64_tr_b16 v[96:97], v18
    ds_read_b64_tr_b16 v[98:99], v18 offset:32768
    ds_read_b64_tr_b16 v[100:101], v19
    ds_read_b64_tr_b16 v[102:103], v19 offset:32768
    ds_read_b64_tr_b16 v[104:105], v20
    ds_read_b64_tr_b16 v[106:107], v20 offset:32768
    ds_read_b64_tr_b16 v[108:109], v21
    ds_read_b64_tr_b16 v[110:111], v21 offset:32768
    ds_read_b64_tr_b16 v[112:113], v22
    ds_read_b64_tr_b16 v[114:115], v22 offset:32768
    ds_read_b64_tr_b16 v[116:117], v23
    ds_read_b64_tr_b16 v[118:119], v23 offset:32768
    buffer_load_dwordx4 v[248:251], v30, s[52:55], s34 offen nt
    s_add_u32 s34, s34, 8192
    buffer_load_dwordx4 v[252:255], v30, s[52:55], s34 offen nt
    s_add_u32 s34, s34, 8192
    v_mul_f32 v32, v32, v126
    v_mul_f32 v33, v33, v126
    v_mul_f32 v34, v34, v126
    v_mul_f32 v35, v35, v126
    v_mul_f32 v36, v36, v126
    v_mul_f32 v37, v37, v126
    v_mul_f32 v38, v38, v126
    v_mul_f32 v39, v39, v126
    v_mul_f32 v40, v40, v126
    v_mul_f32 v41, v41, v126
    v_mul_f32 v42, v42, v126
    v_mul_f32 v43, v43, v126
    v_mul_f32 v44, v44, v126
    v_mul_f32 v45, v45, v126
    v_mul_f32 v46, v46, v126
    v_mul_f32 v47, v47, v126
    v_mul_f32 v48, v48, v126
    v_mul_f32 v49, v49, v126
    v_mul_f32 v50, v50, v126
    v_mul_f32 v51, v51, v126
    v_mul_f32 v52, v52, v126
    v_mul_f32 v53, v53, v126
    v_mul_f32 v54, v54, v126
    v_mul_f32 v55, v55, v126
    v_mul_f32 v56, v56, v126
    v_mul_f32 v57, v57, v126
    v_mul_f32 v58, v58, v126
    v_mul_f32 v59, v59, v126
    v_mul_f32 v60, v60, v126
    v_mul_f32 v61, v61, v126
    v_mul_f32 v62, v62, v126
    v_mul_f32 v63, v63, v126
    s_waitcnt lgkmcnt(14)
    v_mfma_f32_16x16x32_bf16 v[32:35], v[88:91], v[120:123], v[32:35]
    s_waitcnt lgkmcnt(12)
    v_mfma_f32_16x16x32_bf16 v[36:39], v[92:95], v[120:123], v[36:39]
    s_waitcnt lgkmcnt(10)
    v_mfma_f32_16x16x32_bf16 v[40:43], v[96:99], v[120:123], v[40:43]
    s_waitcnt lgkmcnt(8)
    v_mfma_f32_16x16x32_bf16 v[44:47], v[100:103], v[120:123], v[44:47]
    s_waitcnt lgkmcnt(6)
    v_mfma_f32_16x16x32_bf16 v[48:51], v[104:107], v[120:123], v[48:51]
    s_waitcnt lgkmcnt(4)
    v_mfma_f32_16x16x32_bf16 v[52:55], v[108:111], v[120:123], v[52:55]
    s_waitcnt lgkmcnt(2)
    v_mfma_f32_16x16x32_bf16 v[56:59], v[112:115], v[120:123], v[56:59]
    s_waitcnt lgkmcnt(0)
    v_mfma_f32_16x16x32_bf16 v[60:63], v[116:119], v[120:123], v[60:63]
    s_nop 7
    s_nop 1
    s_mul_i32 s98, s3, 4352
    s_movk_i32 s99, 272
    v_mul_lo_u32 v12, v2, s99
    v_lshl_add_u32 v12, v3, 3, v12
    v_add_u32 v12, s98, v12
    v_cvt_pk_bf16_f32 v88, v32, v33
    v_cvt_pk_bf16_f32 v89, v34, v35
    ds_write_b64 v12, v[88:89] offset:0
    v_cvt_pk_bf16_f32 v90, v36, v37
    v_cvt_pk_bf16_f32 v91, v38, v39
    ds_write_b64 v12, v[90:91] offset:32
    v_cvt_pk_bf16_f32 v92, v40, v41
    v_cvt_pk_bf16_f32 v93, v42, v43
    ds_write_b64 v12, v[92:93] offset:64
    v_cvt_pk_bf16_f32 v94, v44, v45
    v_cvt_pk_bf16_f32 v95, v46, v47
    ds_write_b64 v12, v[94:95] offset:96
    v_cvt_pk_bf16_f32 v96, v48, v49
    v_cvt_pk_bf16_f32 v97, v50, v51
    ds_write_b64 v12, v[96:97] offset:128
    v_cvt_pk_bf16_f32 v98, v52, v53
    v_cvt_pk_bf16_f32 v99, v54, v55
    ds_write_b64 v12, v[98:99] offset:160
    v_cvt_pk_bf16_f32 v100, v56, v57
    v_cvt_pk_bf16_f32 v101, v58, v59
    ds_write_b64 v12, v[100:101] offset:192
    v_cvt_pk_bf16_f32 v102, v60, v61
    v_cvt_pk_bf16_f32 v103, v62, v63
    ds_write_b64 v12, v[102:103] offset:224
    v_mul_lo_u32 v12, v3, s99
    v_lshl_add_u32 v12, v2, 4, v12
    v_add_u32 v12, s98, v12
    s_waitcnt lgkmcnt(0)
    ds_read_b128 v[88:91], v12 offset:0
    ds_read_b128 v[92:95], v12 offset:1088
    ds_read_b128 v[96:99], v12 offset:2176
    ds_read_b128 v[100:103], v12 offset:3264
    v_lshlrev_b32 v12, 11, v3
    v_lshl_add_u32 v12, v2, 4, v12
    s_sub_u32 s98, s7, 192
    s_lshl_b32 s98, s98, 15
    s_lshl_b32 s99, s3, 8
    s_add_u32 s98, s98, s99
    s_add_u32 s98, s98, 2097152
    s_waitcnt lgkmcnt(3)
    buffer_store_dwordx4 v[88:91], v12, s[60:63], s98 offen sc1
    s_add_u32 s98, s98, 8192
    s_waitcnt lgkmcnt(2)
    buffer_store_dwordx4 v[92:95], v12, s[60:63], s98 offen sc1
    s_add_u32 s98, s98, 8192
    s_waitcnt lgkmcnt(1)
    buffer_store_dwordx4 v[96:99], v12, s[60:63], s98 offen sc1
    s_add_u32 s98, s98, 8192
    s_waitcnt lgkmcnt(0)
    buffer_store_dwordx4 v[100:103], v12, s[60:63], s98 offen sc1
    s_add_u32 s98, s98, 8192
    v_mov_b32 v13, v125
    s_nop 1
    v_permlane16_swap_b32 v13, v125
    s_nop 1
    v_add_f32 v125, v125, v13
    v_mov_b32 v13, v125
    s_nop 1
    v_permlane32_swap_b32 v13, v125
    s_nop 1
    v_add_f32 v125, v125, v13
    s_cmp_lg_u32 s3, 0
    s_cbranch_scc1 PST_62
    v_lshlrev_b32 v12, 9, v2
    s_sub_u32 s98, s7, 192
    s_lshl_b32 s98, s98, 3
    s_add_u32 s98, s98, 802816
    s_mov_b64 exec, 0xffff
    buffer_store_dwordx2 v[124:125], v12, s[60:63], s98 offen sc1
    s_mov_b64 exec, -1
PST_62:
    s_waitcnt vmcnt(0)
    s_barrier
    s_cmp_lg_u32 s3, 0
    s_cbranch_scc1 FLAG_63
    s_sub_u32 s98, s7, 192
    s_lshl_b32 s98, s98, 2
    s_add_u32 s98, s98, 790528
    v_mov_b32 v13, s4
    s_mov_b64 exec, 1
    buffer_store_dword v13, off, s[60:63], s98 sc1
    s_mov_b64 exec, -1
FLAG_63:
    s_cmp_eq_u32 s3, 0
    s_cbranch_scc1 WOB_64
    s_lshl_b32 s9, s5, 8
    s_lshl_b32 s10, s26, 7
    s_add_u32 s9, s9, s10
    s_mul_i32 s8, s3, 16
    s_add_u32 s8, s8, s9
    s_mul_i32 s8, s8, 896
    v_lshlrev_b32 v12, 4, v1
    s_mov_b32 exec_hi, 0x00ffffff
    buffer_load_dwordx4 v[128:131], v12, s[44:47], s8 offen offset:0
    buffer_load_dwordx4 v[132:135], v12, s[44:47], s8 offen offset:896
    buffer_load_dwordx4 v[136:139], v12, s[44:47], s8 offen offset:1792
    buffer_load_dwordx4 v[140:143], v12, s[44:47], s8 offen offset:2688
    s_add_u32 s8, s8, 3584
    buffer_load_dwordx4 v[144:147], v12, s[44:47], s8 offen offset:0
    buffer_load_dwordx4 v[148:151], v12, s[44:47], s8 offen offset:896
    buffer_load_dwordx4 v[152:155], v12, s[44:47], s8 offen offset:1792
    buffer_load_dwordx4 v[156:159], v12, s[44:47], s8 offen offset:2688
    s_add_u32 s8, s8, 3584
    buffer_load_dwordx4 v[160:163], v12, s[44:47], s8 offen offset:0
    buffer_load_dwordx4 v[164:167], v12, s[44:47], s8 offen offset:896
    buffer_load_dwordx4 v[168:171], v12, s[44:47], s8 offen offset:1792
    buffer_load_dwordx4 v[172:175], v12, s[44:47], s8 offen offset:2688
    s_add_u32 s8, s8, 3584
    buffer_load_dwordx4 v[176:179], v12, s[44:47], s8 offen offset:0
    buffer_load_dwordx4 v[180:183], v12, s[44:47], s8 offen offset:896
    buffer_load_dwordx4 v[184:187], v12, s[44:47], s8 offen offset:1792
    buffer_load_dwordx4 v[188:191], v12, s[44:47], s8 offen offset:2688
    s_mov_b32 exec_hi, -1
WOB_64:
    s_cmp_lg_u32 s3, 0
    s_cbranch_scc1 POLLOK_66
    v_lshlrev_b32 v12, 2, v1
    s_mov_b32 s98, 790528
    s_mov_b32 s75, 0
POLL_65:
    buffer_load_dword v13, v12, s[60:63], s98 offen sc1
    s_waitcnt vmcnt(0)
    v_cmp_eq_u32 vcc, s4, v13
    s_cmp_eq_u64 vcc, exec
    s_cbranch_scc1 POLLOK_66
    s_add_u32 s75, s75, 1
    s_cmp_gt_u32 s75, 400000
    s_cbranch_scc1 POLLOK_66
    s_sleep 4
    s_branch POLL_65
POLLOK_66:
    s_mov_b64 exec, -1
    s_barrier
    v_lshlrev_b32 v12, 3, v1
    s_lshl_b32 s98, s5, 9
    s_add_u32 s98, s98, 802816
    buffer_load_dwordx2 v[14:15], v12, s[60:63], s98 offen sc1
    v_lshlrev_b32 v13, 4, v1
    s_lshl_b32 s98, s3, 18
    s_lshl_b32 s99, s5, 11
    s_add_u32 s98, s98, s99
    s_lshr_b32 s99, s6, 1
    s_lshl_b32 s99, s99, 10
    s_add_u32 s98, s98, s99
    s_add_u32 s98, s98, 2097152
    buffer_load_dwordx4 v[64:67], v13, s[60:63], s98 offen sc1
    s_add_u32 s98, s98, 32768
    buffer_load_dwordx4 v[68:71], v13, s[60:63], s98 offen sc1
    s_add_u32 s98, s98, 32768
    buffer_load_dwordx4 v[72:75], v13, s[60:63], s98 offen sc1
    s_add_u32 s98, s98, 32768
    buffer_load_dwordx4 v[76:79], v13, s[60:63], s98 offen sc1
    s_add_u32 s98, s98, 32768
    buffer_load_dwordx4 v[80:83], v13, s[60:63], s98 offen sc1
    s_add_u32 s98, s98, 32768
    buffer_load_dwordx4 v[84:87], v13, s[60:63], s98 offen sc1
    s_add_u32 s98, s98, 32768
    buffer_load_dwordx4 v[88:91], v13, s[60:63], s98 offen sc1
    s_add_u32 s98, s98, 32768
    buffer_load_dwordx4 v[92:95], v13, s[60:63], s98 offen sc1
    s_add_u32 s98, s98, 32768
    s_waitcnt vmcnt(8)
    v_mov_b32 v12, v14
    s_nop 1
    v_max_f32_dpp v12, v12, v12 row_ror:8 row_mask:0xf bank_mask:0xf
    s_nop 1
    v_max_f32_dpp v12, v12, v12 row_ror:4 row_mask:0xf bank_mask:0xf
    s_nop 1
    v_max_f32_dpp v12, v12, v12 row_ror:2 row_mask:0xf bank_mask:0xf
    s_nop 1
    v_max_f32_dpp v12, v12, v12 row_ror:1 row_mask:0xf bank_mask:0xf
    v_mov_b32 v13, v12
    s_nop 1
    v_permlane16_swap_b32 v13, v12
    s_nop 1
    v_max_f32 v12, v12, v13
    v_sub_f32 v12, v14, v12
    v_exp_f32 v12, v12
    s_nop 0
    v_mul_f32 v13, v12, v15
    s_nop 1
    v_add_f32_dpp v13, v13, v13 row_ror:8 row_mask:0xf bank_mask:0xf
    s_nop 1
    v_add_f32_dpp v13, v13, v13 row_ror:4 row_mask:0xf bank_mask:0xf
    s_nop 1
    v_add_f32_dpp v13, v13, v13 row_ror:2 row_mask:0xf bank_mask:0xf
    s_nop 1
    v_add_f32_dpp v13, v13, v13 row_ror:1 row_mask:0xf bank_mask:0xf
    v_mov_b32 v14, v13
    s_nop 1
    v_permlane16_swap_b32 v14, v13
    s_nop 1
    v_add_f32 v13, v13, v14
    v_rcp_f32 v13, v13
    s_nop 0
    v_mul_f32 v12, v12, v13
    s_lshl_b32 s98, s3, 3
    s_nop 1
    v_readlane_b32 s82, v12, s98
    s_add_u32 s98, s98, 1
    v_readlane_b32 s83, v12, s98
    s_add_u32 s98, s98, 1
    v_readlane_b32 s84, v12, s98
    s_add_u32 s98, s98, 1
    v_readlane_b32 s85, v12, s98
    s_add_u32 s98, s98, 1
    v_readlane_b32 s86, v12, s98
    s_add_u32 s98, s98, 1
    v_readlane_b32 s87, v12, s98
    s_add_u32 s98, s98, 1
    v_readlane_b32 s88, v12, s98
    s_add_u32 s98, s98, 1
    v_readlane_b32 s89, v12, s98
    s_add_u32 s98, s98, 1
    v_mov_b32 v32, 0
    v_mov_b32 v33, 0
    v_mov_b32 v34, 0
    v_mov_b32 v35, 0
    v_mov_b32 v36, 0
    v_mov_b32 v37, 0
    v_mov_b32 v38, 0
    v_mov_b32 v39, 0
    s_waitcnt vmcnt(7)
    v_lshlrev_b32 v12, 16, v64
    v_and_b32 v13, 0xffff0000, v64
    v_fmac_f32 v32, s82, v12
    v_fmac_f32 v33, s82, v13
    v_lshlrev_b32 v12, 16, v65
    v_and_b32 v13, 0xffff0000, v65
    v_fmac_f32 v34, s82, v12
    v_fmac_f32 v35, s82, v13
    v_lshlrev_b32 v12, 16, v66
    v_and_b32 v13, 0xffff0000, v66
    v_fmac_f32 v36, s82, v12
    v_fmac_f32 v37, s82, v13
    v_lshlrev_b32 v12, 16, v67
    v_and_b32 v13, 0xffff0000, v67
    v_fmac_f32 v38, s82, v12
    v_fmac_f32 v39, s82, v13
    s_waitcnt vmcnt(6)
    v_lshlrev_b32 v12, 16, v68
    v_and_b32 v13, 0xffff0000, v68
    v_fmac_f32 v32, s83, v12
    v_fmac_f32 v33, s83, v13
    v_lshlrev_b32 v12, 16, v69
    v_and_b32 v13, 0xffff0000, v69
    v_fmac_f32 v34, s83, v12
    v_fmac_f32 v35, s83, v13
    v_lshlrev_b32 v12, 16, v70
    v_and_b32 v13, 0xffff0000, v70
    v_fmac_f32 v36, s83, v12
    v_fmac_f32 v37, s83, v13
    v_lshlrev_b32 v12, 16, v71
    v_and_b32 v13, 0xffff0000, v71
    v_fmac_f32 v38, s83, v12
    v_fmac_f32 v39, s83, v13
    s_waitcnt vmcnt(5)
    v_lshlrev_b32 v12, 16, v72
    v_and_b32 v13, 0xffff0000, v72
    v_fmac_f32 v32, s84, v12
    v_fmac_f32 v33, s84, v13
    v_lshlrev_b32 v12, 16, v73
    v_and_b32 v13, 0xffff0000, v73
    v_fmac_f32 v34, s84, v12
    v_fmac_f32 v35, s84, v13
    v_lshlrev_b32 v12, 16, v74
    v_and_b32 v13, 0xffff0000, v74
    v_fmac_f32 v36, s84, v12
    v_fmac_f32 v37, s84, v13
    v_lshlrev_b32 v12, 16, v75
    v_and_b32 v13, 0xffff0000, v75
    v_fmac_f32 v38, s84, v12
    v_fmac_f32 v39, s84, v13
    s_waitcnt vmcnt(4)
    v_lshlrev_b32 v12, 16, v76
    v_and_b32 v13, 0xffff0000, v76
    v_fmac_f32 v32, s85, v12
    v_fmac_f32 v33, s85, v13
    v_lshlrev_b32 v12, 16, v77
    v_and_b32 v13, 0xffff0000, v77
    v_fmac_f32 v34, s85, v12
    v_fmac_f32 v35, s85, v13
    v_lshlrev_b32 v12, 16, v78
    v_and_b32 v13, 0xffff0000, v78
    v_fmac_f32 v36, s85, v12
    v_fmac_f32 v37, s85, v13
    v_lshlrev_b32 v12, 16, v79
    v_and_b32 v13, 0xffff0000, v79
    v_fmac_f32 v38, s85, v12
    v_fmac_f32 v39, s85, v13
    s_waitcnt vmcnt(3)
    v_lshlrev_b32 v12, 16, v80
    v_and_b32 v13, 0xffff0000, v80
    v_fmac_f32 v32, s86, v12
    v_fmac_f32 v33, s86, v13
    v_lshlrev_b32 v12, 16, v81
    v_and_b32 v13, 0xffff0000, v81
    v_fmac_f32 v34, s86, v12
    v_fmac_f32 v35, s86, v13
    v_lshlrev_b32 v12, 16, v82
    v_and_b32 v13, 0xffff0000, v82
    v_fmac_f32 v36, s86, v12
    v_fmac_f32 v37, s86, v13
    v_lshlrev_b32 v12, 16, v83
    v_and_b32 v13, 0xffff0000, v83
    v_fmac_f32 v38, s86, v12
    v_fmac_f32 v39, s86, v13
    s_waitcnt vmcnt(2)
    v_lshlrev_b32 v12, 16, v84
    v_and_b32 v13, 0xffff0000, v84
    v_fmac_f32 v32, s87, v12
    v_fmac_f32 v33, s87, v13
    v_lshlrev_b32 v12, 16, v85
    v_and_b32 v13, 0xffff0000, v85
    v_fmac_f32 v34, s87, v12
    v_fmac_f32 v35, s87, v13
    v_lshlrev_b32 v12, 16, v86
    v_and_b32 v13, 0xffff0000, v86
    v_fmac_f32 v36, s87, v12
    v_fmac_f32 v37, s87, v13
    v_lshlrev_b32 v12, 16, v87
    v_and_b32 v13, 0xffff0000, v87
    v_fmac_f32 v38, s87, v12
    v_fmac_f32 v39, s87, v13
    s_waitcnt vmcnt(1)
    v_lshlrev_b32 v12, 16, v88
    v_and_b32 v13, 0xffff0000, v88
    v_fmac_f32 v32, s88, v12
    v_fmac_f32 v33, s88, v13
    v_lshlrev_b32 v12, 16, v89
    v_and_b32 v13, 0xffff0000, v89
    v_fmac_f32 v34, s88, v12
    v_fmac_f32 v35, s88, v13
    v_lshlrev_b32 v12, 16, v90
    v_and_b32 v13, 0xffff0000, v90
    v_fmac_f32 v36, s88, v12
    v_fmac_f32 v37, s88, v13
    v_lshlrev_b32 v12, 16, v91
    v_and_b32 v13, 0xffff0000, v91
    v_fmac_f32 v38, s88, v12
    v_fmac_f32 v39, s88, v13
    s_waitcnt vmcnt(0)
    v_lshlrev_b32 v12, 16, v92
    v_and_b32 v13, 0xffff0000, v92
    v_fmac_f32 v32, s89, v12
    v_fmac_f32 v33, s89, v13
    v_lshlrev_b32 v12, 16, v93
    v_and_b32 v13, 0xffff0000, v93
    v_fmac_f32 v34, s89, v12
    v_fmac_f32 v35, s89, v13
    v_lshlrev_b32 v12, 16, v94
    v_and_b32 v13, 0xffff0000, v94
    v_fmac_f32 v36, s89, v12
    v_fmac_f32 v37, s89, v13
    v_lshlrev_b32 v12, 16, v95
    v_and_b32 v13, 0xffff0000, v95
    v_fmac_f32 v38, s89, v12
    v_fmac_f32 v39, s89, v13
    s_cmp_lg_u32 s3, 0
    s_cbranch_scc1 WOB0_67
    s_lshl_b32 s9, s5, 8
    s_lshl_b32 s10, s26, 7
    s_add_u32 s9, s9, s10
    s_mul_i32 s8, s3, 16
    s_add_u32 s8, s8, s9
    s_mul_i32 s8, s8, 896
    v_lshlrev_b32 v12, 4, v1
    s_mov_b32 exec_hi, 0x00ffffff
    buffer_load_dwordx4 v[128:131], v12, s[44:47], s8 offen offset:0
    buffer_load_dwordx4 v[132:135], v12, s[44:47], s8 offen offset:896
    buffer_load_dwordx4 v[136:139], v12, s[44:47], s8 offen offset:1792
    buffer_load_dwordx4 v[140:143], v12, s[44:47], s8 offen offset:2688
    s_add_u32 s8, s8, 3584
    buffer_load_dwordx4 v[144:147], v12, s[44:47], s8 offen offset:0
    buffer_load_dwordx4 v[148:151], v12, s[44:47], s8 offen offset:896
    buffer_load_dwordx4 v[152:155], v12, s[44:47], s8 offen offset:1792
    buffer_load_dwordx4 v[156:159], v12, s[44:47], s8 offen offset:2688
    s_add_u32 s8, s8, 3584
    buffer_load_dwordx4 v[160:163], v12, s[44:47], s8 offen offset:0
    buffer_load_dwordx4 v[164:167], v12, s[44:47], s8 offen offset:896
    buffer_load_dwordx4 v[168:171], v12, s[44:47], s8 offen offset:1792
    buffer_load_dwordx4 v[172:175], v12, s[44:47], s8 offen offset:2688
    s_add_u32 s8, s8, 3584
    buffer_load_dwordx4 v[176:179], v12, s[44:47], s8 offen offset:0
    buffer_load_dwordx4 v[180:183], v12, s[44:47], s8 offen offset:896
    buffer_load_dwordx4 v[184:187], v12, s[44:47], s8 offen offset:1792
    buffer_load_dwordx4 v[188:191], v12, s[44:47], s8 offen offset:2688
    s_mov_b32 exec_hi, -1
WOB0_67:
    s_and_b32 s98, s3, 3
    s_lshl_b32 s98, s98, 12
    s_lshr_b32 s99, s3, 2
    s_lshl_b32 s99, s99, 11
    s_add_u32 s98, s98, s99
    s_add_u32 s98, s98, 16384
    v_lshlrev_b32 v13, 5, v1
    v_add_u32 v13, s98, v13
    ds_write_b128 v13, v[32:35]
    ds_write_b128 v13, v[36:39] offset:16
    s_waitcnt lgkmcnt(0)
    s_barrier
    v_lshlrev_b32 v12, 3, v0
    v_add_u32 v12, 16384, v12
    ds_read_b64 v[32:33], v12 offset:0
    ds_read_b64 v[34:35], v12 offset:4096
    ds_read_b64 v[36:37], v12 offset:8192
    ds_read_b64 v[38:39], v12 offset:12288
    s_waitcnt lgkmcnt(0)
    v_add_f32 v32, v32, v34
    v_add_f32 v33, v33, v35
    v_add_f32 v36, v36, v38
    v_add_f32 v37, v37, v39
    v_add_f32 v32, v32, v36
    v_add_f32 v33, v33, v37
    v_cvt_pk_bf16_f32 v32, v32, v33
    v_lshlrev_b32 v12, 2, v0
    v_add_u32 v12, 12288, v12
    ds_write_b32 v12, v32
    s_waitcnt lgkmcnt(0)
    s_barrier
    v_lshlrev_b32 v12, 5, v3
    s_lshl_b32 s98, s3, 7
    s_add_u32 s98, s98, 12288
    v_add_u32 v12, s98, v12
    ds_read_b128 v[64:67], v12 offset:0
    ds_read_b128 v[68:71], v12 offset:16
    ds_read_b128 v[72:75], v12 offset:1024
    ds_read_b128 v[76:79], v12 offset:1040
    v_mov_b32 v32, 0
    v_mov_b32 v33, 0
    v_mov_b32 v34, 0
    v_mov_b32 v35, 0
    v_mov_b32 v36, 0
    v_mov_b32 v37, 0
    v_mov_b32 v38, 0
    v_mov_b32 v39, 0
    v_mov_b32 v40, 0
    v_mov_b32 v41, 0
    v_mov_b32 v42, 0
    v_mov_b32 v43, 0
    v_mov_b32 v44, 0
    v_mov_b32 v45, 0
    v_mov_b32 v46, 0
    v_mov_b32 v47, 0
    s_waitcnt lgkmcnt(0)
    v_perm_b32 v100, v196, v192, s72
    v_perm_b32 v101, v196, v192, s73
    v_perm_b32 v102, v197, v193, s72
    v_perm_b32 v103, v197, v193, s73
    v_perm_b32 v104, v198, v194, s72
    v_perm_b32 v105, v198, v194, s73
    v_perm_b32 v106, v199, v195, s72
    v_perm_b32 v107, v199, v195, s73
    v_dot2_f32_bf16 v32, v100, v64, v32
    v_dot2_f32_bf16 v33, v101, v64, v33
    v_dot2_f32_bf16 v34, v102, v64, v34
    v_dot2_f32_bf16 v35, v103, v64, v35
    v_dot2_f32_bf16 v36, v104, v64, v36
    v_dot2_f32_bf16 v37, v105, v64, v37
    v_dot2_f32_bf16 v38, v106, v64, v38
    v_dot2_f32_bf16 v39, v107, v64, v39
    v_dot2_f32_bf16 v40, v100, v72, v40
    v_dot2_f32_bf16 v41, v101, v72, v41
    v_dot2_f32_bf16 v42, v102, v72, v42
    v_dot2_f32_bf16 v43, v103, v72, v43
    v_dot2_f32_bf16 v44, v104, v72, v44
    v_dot2_f32_bf16 v45, v105, v72, v45
    v_dot2_f32_bf16 v46, v106, v72, v46
    v_dot2_f32_bf16 v47, v107, v72, v47
    v_perm_b32 v100, v204, v200, s72
    v_perm_b32 v101, v204, v200, s73
    v_perm_b32 v102, v205, v201, s72
    v_perm_b32 v103, v205, v201, s73
    v_perm_b32 v104, v206, v202, s72
    v_perm_b32 v105, v206, v202, s73
    v_perm_b32 v106, v207, v203, s72
    v_perm_b32 v107, v207, v203, s73
    v_dot2_f32_bf16 v32, v100, v65, v32
    v_dot2_f32_bf16 v33, v101, v65, v33
    v_dot2_f32_bf16 v34, v102, v65, v34
    v_dot2_f32_bf16 v35, v103, v65, v35
    v_dot2_f32_bf16 v36, v104, v65, v36
    v_dot2_f32_bf16 v37, v105, v65, v37
    v_dot2_f32_bf16 v38, v106, v65, v38
    v_dot2_f32_bf16 v39, v107, v65, v39
    v_dot2_f32_bf16 v40, v100, v73, v40
    v_dot2_f32_bf16 v41, v101, v73, v41
    v_dot2_f32_bf16 v42, v102, v73, v42
    v_dot2_f32_bf16 v43, v103, v73, v43
    v_dot2_f32_bf16 v44, v104, v73, v44
    v_dot2_f32_bf16 v45, v105, v73, v45
    v_dot2_f32_bf16 v46, v106, v73, v46
    v_dot2_f32_bf16 v47, v107, v73, v47
    v_perm_b32 v100, v212, v208, s72
    v_perm_b32 v101, v212, v208, s73
    v_perm_b32 v102, v213, v209, s72
    v_perm_b32 v103, v213, v209, s73
    v_perm_b32 v104, v214, v210, s72
    v_perm_b32 v105, v214, v210, s73
    v_perm_b32 v106, v215, v211, s72
    v_perm_b32 v107, v215, v211, s73
    v_dot2_f32_bf16 v32, v100, v66, v32
    v_dot2_f32_bf16 v33, v101, v66, v33
    v_dot2_f32_bf16 v34, v102, v66, v34
    v_dot2_f32_bf16 v35, v103, v66, v35
    v_dot2_f32_bf16 v36, v104, v66, v36
    v_dot2_f32_bf16 v37, v105, v66, v37
    v_dot2_f32_bf16 v38, v106, v66, v38
    v_dot2_f32_bf16 v39, v107, v66, v39
    v_dot2_f32_bf16 v40, v100, v74, v40
    v_dot2_f32_bf16 v41, v101, v74, v41
    v_dot2_f32_bf16 v42, v102, v74, v42
    v_dot2_f32_bf16 v43, v103, v74, v43
    v_dot2_f32_bf16 v44, v104, v74, v44
    v_dot2_f32_bf16 v45, v105, v74, v45
    v_dot2_f32_bf16 v46, v106, v74, v46
    v_dot2_f32_bf16 v47, v107, v74, v47
    v_perm_b32 v100, v220, v216, s72
    v_perm_b32 v101, v220, v216, s73
    v_perm_b32 v102, v221, v217, s72
    v_perm_b32 v103, v221, v217, s73
    v_perm_b32 v104, v222, v218, s72
    v_perm_b32 v105, v222, v218, s73
    v_perm_b32 v106, v223, v219, s72
    v_perm_b32 v107, v223, v219, s73
    v_dot2_f32_bf16 v32, v100, v67, v32
    v_dot2_f32_bf16 v33, v101, v67, v33
    v_dot2_f32_bf16 v34, v102, v67, v34
    v_dot2_f32_bf16 v35, v103, v67, v35
    v_dot2_f32_bf16 v36, v104, v67, v36
    v_dot2_f32_bf16 v37, v105, v67, v37
    v_dot2_f32_bf16 v38, v106, v67, v38
    v_dot2_f32_bf16 v39, v107, v67, v39
    v_dot2_f32_bf16 v40, v100, v75, v40
    v_dot2_f32_bf16 v41, v101, v75, v41
    v_dot2_f32_bf16 v42, v102, v75, v42
    v_dot2_f32_bf16 v43, v103, v75, v43
    v_dot2_f32_bf16 v44, v104, v75, v44
    v_dot2_f32_bf16 v45, v105, v75, v45
    v_dot2_f32_bf16 v46, v106, v75, v46
    v_dot2_f32_bf16 v47, v107, v75, v47
    v_perm_b32 v100, v228, v224, s72
    v_perm_b32 v101, v228, v224, s73
    v_perm_b32 v102, v229, v225, s72
    v_perm_b32 v103, v229, v225, s73
    v_perm_b32 v104, v230, v226, s72
    v_perm_b32 v105, v230, v226, s73
    v_perm_b32 v106, v231, v227, s72
    v_perm_b32 v107, v231, v227, s73
    v_dot2_f32_bf16 v32, v100, v68, v32
    v_dot2_f32_bf16 v33, v101, v68, v33
    v_dot2_f32_bf16 v34, v102, v68, v34
    v_dot2_f32_bf16 v35, v103, v68, v35
    v_dot2_f32_bf16 v36, v104, v68, v36
    v_dot2_f32_bf16 v37, v105, v68, v37
    v_dot2_f32_bf16 v38, v106, v68, v38
    v_dot2_f32_bf16 v39, v107, v68, v39
    v_dot2_f32_bf16 v40, v100, v76, v40
    v_dot2_f32_bf16 v41, v101, v76, v41
    v_dot2_f32_bf16 v42, v102, v76, v42
    v_dot2_f32_bf16 v43, v103, v76, v43
    v_dot2_f32_bf16 v44, v104, v76, v44
    v_dot2_f32_bf16 v45, v105, v76, v45
    v_dot2_f32_bf16 v46, v106, v76, v46
    v_dot2_f32_bf16 v47, v107, v76, v47
    v_perm_b32 v100, v236, v232, s72
    v_perm_b32 v101, v236, v232, s73
    v_perm_b32 v102, v237, v233, s72
    v_perm_b32 v103, v237, v233, s73
    v_perm_b32 v104, v238, v234, s72
    v_perm_b32 v105, v238, v234, s73
    v_perm_b32 v106, v239, v235, s72
    v_perm_b32 v107, v239, v235, s73
    v_dot2_f32_bf16 v32, v100, v69, v32
    v_dot2_f32_bf16 v33, v101, v69, v33
    v_dot2_f32_bf16 v34, v102, v69, v34
    v_dot2_f32_bf16 v35, v103, v69, v35
    v_dot2_f32_bf16 v36, v104, v69, v36
    v_dot2_f32_bf16 v37, v105, v69, v37
    v_dot2_f32_bf16 v38, v106, v69, v38
    v_dot2_f32_bf16 v39, v107, v69, v39
    v_dot2_f32_bf16 v40, v100, v77, v40
    v_dot2_f32_bf16 v41, v101, v77, v41
    v_dot2_f32_bf16 v42, v102, v77, v42
    v_dot2_f32_bf16 v43, v103, v77, v43
    v_dot2_f32_bf16 v44, v104, v77, v44
    v_dot2_f32_bf16 v45, v105, v77, v45
    v_dot2_f32_bf16 v46, v106, v77, v46
    v_dot2_f32_bf16 v47, v107, v77, v47
    v_perm_b32 v100, v244, v240, s72
    v_perm_b32 v101, v244, v240, s73
    v_perm_b32 v102, v245, v241, s72
    v_perm_b32 v103, v245, v241, s73
    v_perm_b32 v104, v246, v242, s72
    v_perm_b32 v105, v246, v242, s73
    v_perm_b32 v106, v247, v243, s72
    v_perm_b32 v107, v247, v243, s73
    v_dot2_f32_bf16 v32, v100, v70, v32
    v_dot2_f32_bf16 v33, v101, v70, v33
    v_dot2_f32_bf16 v34, v102, v70, v34
    v_dot2_f32_bf16 v35, v103, v70, v35
    v_dot2_f32_bf16 v36, v104, v70, v36
    v_dot2_f32_bf16 v37, v105, v70, v37
    v_dot2_f32_bf16 v38, v106, v70, v38
    v_dot2_f32_bf16 v39, v107, v70, v39
    v_dot2_f32_bf16 v40, v100, v78, v40
    v_dot2_f32_bf16 v41, v101, v78, v41
    v_dot2_f32_bf16 v42, v102, v78, v42
    v_dot2_f32_bf16 v43, v103, v78, v43
    v_dot2_f32_bf16 v44, v104, v78, v44
    v_dot2_f32_bf16 v45, v105, v78, v45
    v_dot2_f32_bf16 v46, v106, v78, v46
    v_dot2_f32_bf16 v47, v107, v78, v47
    v_perm_b32 v100, v252, v248, s72
    v_perm_b32 v101, v252, v248, s73
    v_perm_b32 v102, v253, v249, s72
    v_perm_b32 v103, v253, v249, s73
    v_perm_b32 v104, v254, v250, s72
    v_perm_b32 v105, v254, v250, s73
    v_perm_b32 v106, v255, v251, s72
    v_perm_b32 v107, v255, v251, s73
    v_dot2_f32_bf16 v32, v100, v71, v32
    v_dot2_f32_bf16 v33, v101, v71, v33
    v_dot2_f32_bf16 v34, v102, v71, v34
    v_dot2_f32_bf16 v35, v103, v71, v35
    v_dot2_f32_bf16 v36, v104, v71, v36
    v_dot2_f32_bf16 v37, v105, v71, v37
    v_dot2_f32_bf16 v38, v106, v71, v38
    v_dot2_f32_bf16 v39, v107, v71, v39
    v_dot2_f32_bf16 v40, v100, v79, v40
    v_dot2_f32_bf16 v41, v101, v79, v41
    v_dot2_f32_bf16 v42, v102, v79, v42
    v_dot2_f32_bf16 v43, v103, v79, v43
    v_dot2_f32_bf16 v44, v104, v79, v44
    v_dot2_f32_bf16 v45, v105, v79, v45
    v_dot2_f32_bf16 v46, v106, v79, v46
    v_dot2_f32_bf16 v47, v107, v79, v47
    s_nop 3
    s_nop 1
    v_permlane32_swap_b32 v32, v40
    v_permlane32_swap_b32 v33, v41
    v_permlane32_swap_b32 v34, v42
    v_permlane32_swap_b32 v35, v43
    v_permlane32_swap_b32 v36, v44
    v_permlane32_swap_b32 v37, v45
    v_permlane32_swap_b32 v38, v46
    v_permlane32_swap_b32 v39, v47
    s_nop 1
    v_add_f32 v32, v32, v40
    v_add_f32 v33, v33, v41
    v_add_f32 v34, v34, v42
    v_add_f32 v35, v35, v43
    v_add_f32 v36, v36, v44
    v_add_f32 v37, v37, v45
    v_add_f32 v38, v38, v46
    v_add_f32 v39, v39, v47
    s_nop 1
    v_permlane16_swap_b32 v32, v36
    v_permlane16_swap_b32 v33, v37
    v_permlane16_swap_b32 v34, v38
    v_permlane16_swap_b32 v35, v39
    s_nop 1
    v_add_f32 v32, v32, v36
    v_add_f32 v33, v33, v37
    v_add_f32 v34, v34, v38
    v_add_f32 v35, v35, v39
    v_lshrrev_b32 v12, 1, v3
    v_lshlrev_b32 v12, 9, v12
    v_and_b32 v13, 1, v3
    v_lshl_add_u32 v12, v13, 4, v12
    v_lshl_add_u32 v12, v2, 5, v12
    s_lshl_b32 s98, s3, 10
    v_add_u32 v12, s98, v12
    ds_write_b128 v12, v[32:35] offset:0
    s_waitcnt lgkmcnt(0)
    s_barrier
    s_cmp_ge_u32 s3, 4
    s_cbranch_scc1 OBS_68
    v_lshlrev_b32 v12, 2, v0
    ds_read_b32 v32, v12 offset:0
    ds_read_b32 v33, v12 offset:1024
    ds_read_b32 v34, v12 offset:2048
    ds_read_b32 v35, v12 offset:3072
    ds_read_b32 v36, v12 offset:4096
    ds_read_b32 v37, v12 offset:5120
    ds_read_b32 v38, v12 offset:6144
    ds_read_b32 v39, v12 offset:7168
    s_waitcnt lgkmcnt(0)
    v_add_f32 v32, v32, v33
    v_add_f32 v32, v32, v34
    v_add_f32 v32, v32, v35
    v_add_f32 v32, v32, v36
    v_add_f32 v32, v32, v37
    v_add_f32 v32, v32, v38
    v_add_f32 v32, v32, v39
    v_cvt_pk_bf16_f32 v32, v32, v32
    v_lshlrev_b32 v12, 1, v0
    ds_write_b16 v12, v32 offset:8192
OBS_68:
    s_waitcnt lgkmcnt(0)
    s_barrier
    s_waitcnt vmcnt(0)
    v_perm_b32 v12, v132, v128, s72
    v_perm_b32 v132, v132, v128, s73
    v_mov_b32 v128, v12
    v_perm_b32 v12, v133, v129, s72
    v_perm_b32 v133, v133, v129, s73
    v_mov_b32 v129, v12
    v_perm_b32 v12, v134, v130, s72
    v_perm_b32 v134, v134, v130, s73
    v_mov_b32 v130, v12
    v_perm_b32 v12, v135, v131, s72
    v_perm_b32 v135, v135, v131, s73
    v_mov_b32 v131, v12
    v_perm_b32 v12, v140, v136, s72
    v_perm_b32 v140, v140, v136, s73
    v_mov_b32 v136, v12
    v_perm_b32 v12, v141, v137, s72
    v_perm_b32 v141, v141, v137, s73
    v_mov_b32 v137, v12
    v_perm_b32 v12, v142, v138, s72
    v_perm_b32 v142, v142, v138, s73
    v_mov_b32 v138, v12
    v_perm_b32 v12, v143, v139, s72
    v_perm_b32 v143, v143, v139, s73
    v_mov_b32 v139, v12
    v_perm_b32 v12, v148, v144, s72
    v_perm_b32 v148, v148, v144, s73
    v_mov_b32 v144, v12
    v_perm_b32 v12, v149, v145, s72
    v_perm_b32 v149, v149, v145, s73
    v_mov_b32 v145, v12
    v_perm_b32 v12, v150, v146, s72
    v_perm_b32 v150, v150, v146, s73
    v_mov_b32 v146, v12
    v_perm_b32 v12, v151, v147, s72
    v_perm_b32 v151, v151, v147, s73
    v_mov_b32 v147, v12
    v_perm_b32 v12, v156, v152, s72
    v_perm_b32 v156, v156, v152, s73
    v_mov_b32 v152, v12
    v_perm_b32 v12, v157, v153, s72
    v_perm_b32 v157, v157, v153, s73
    v_mov_b32 v153, v12
    v_perm_b32 v12, v158, v154, s72
    v_perm_b32 v158, v158, v154, s73
    v_mov_b32 v154, v12
    v_perm_b32 v12, v159, v155, s72
    v_perm_b32 v159, v159, v155, s73
    v_mov_b32 v155, v12
    v_perm_b32 v12, v164, v160, s72
    v_perm_b32 v164, v164, v160, s73
    v_mov_b32 v160, v12
    v_perm_b32 v12, v165, v161, s72
    v_perm_b32 v165, v165, v161, s73
    v_mov_b32 v161, v12
    v_perm_b32 v12, v166, v162, s72
    v_perm_b32 v166, v166, v162, s73
    v_mov_b32 v162, v12
    v_perm_b32 v12, v167, v163, s72
    v_perm_b32 v167, v167, v163, s73
    v_mov_b32 v163, v12
    v_perm_b32 v12, v172, v168, s72
    v_perm_b32 v172, v172, v168, s73
    v_mov_b32 v168, v12
    v_perm_b32 v12, v173, v169, s72
    v_perm_b32 v173, v173, v169, s73
    v_mov_b32 v169, v12
    v_perm_b32 v12, v174, v170, s72
    v_perm_b32 v174, v174, v170, s73
    v_mov_b32 v170, v12
    v_perm_b32 v12, v175, v171, s72
    v_perm_b32 v175, v175, v171, s73
    v_mov_b32 v171, v12
    v_perm_b32 v12, v180, v176, s72
    v_perm_b32 v180, v180, v176, s73
    v_mov_b32 v176, v12
    v_perm_b32 v12, v181, v177, s72
    v_perm_b32 v181, v181, v177, s73
    v_mov_b32 v177, v12
    v_perm_b32 v12, v182, v178, s72
    v_perm_b32 v182, v182, v178, s73
    v_mov_b32 v178, v12
    v_perm_b32 v12, v183, v179, s72
    v_perm_b32 v183, v183, v179, s73
    v_mov_b32 v179, v12
    v_perm_b32 v12, v188, v184, s72
    v_perm_b32 v188, v188, v184, s73
    v_mov_b32 v184, v12
    v_perm_b32 v12, v189, v185, s72
    v_perm_b32 v189, v189, v185, s73
    v_mov_b32 v185, v12
    v_perm_b32 v12, v190, v186, s72
    v_perm_b32 v190, v190, v186, s73
    v_mov_b32 v186, v12
    v_perm_b32 v12, v191, v187, s72
    v_perm_b32 v191, v191, v187, s73
    v_mov_b32 v187, v12
    s_mul_i32 s8, s3, 32
    s_add_u32 s8, s8, 8192
    v_mov_b32 v12, s8
    ds_read_b128 v[32:35], v12 offset:0
    ds_read_b128 v[36:39], v12 offset:16
    ds_read_b128 v[40:43], v12 offset:256
    ds_read_b128 v[44:47], v12 offset:272
    v_mov_b32 v48, 0
    v_mov_b32 v49, 0
    v_mov_b32 v50, 0
    v_mov_b32 v51, 0
    v_mov_b32 v52, 0
    v_mov_b32 v53, 0
    v_mov_b32 v54, 0
    v_mov_b32 v55, 0
    v_mov_b32 v56, 0
    v_mov_b32 v57, 0
    v_mov_b32 v58, 0
    v_mov_b32 v59, 0
    v_mov_b32 v60, 0
    v_mov_b32 v61, 0
    v_mov_b32 v62, 0
    v_mov_b32 v63, 0
    s_waitcnt lgkmcnt(0)
    v_dot2_f32_bf16 v48, v128, v32, v48
    v_dot2_f32_bf16 v49, v132, v32, v49
    v_dot2_f32_bf16 v50, v129, v32, v50
    v_dot2_f32_bf16 v51, v133, v32, v51
    v_dot2_f32_bf16 v52, v130, v32, v52
    v_dot2_f32_bf16 v53, v134, v32, v53
    v_dot2_f32_bf16 v54, v131, v32, v54
    v_dot2_f32_bf16 v55, v135, v32, v55
    v_dot2_f32_bf16 v56, v128, v40, v56
    v_dot2_f32_bf16 v57, v132, v40, v57
    v_dot2_f32_bf16 v58, v129, v40, v58
    v_dot2_f32_bf16 v59, v133, v40, v59
    v_dot2_f32_bf16 v60, v130, v40, v60
    v_dot2_f32_bf16 v61, v134, v40, v61
    v_dot2_f32_bf16 v62, v131, v40, v62
    v_dot2_f32_bf16 v63, v135, v40, v63
    v_dot2_f32_bf16 v48, v136, v33, v48
    v_dot2_f32_bf16 v49, v140, v33, v49
    v_dot2_f32_bf16 v50, v137, v33, v50
    v_dot2_f32_bf16 v51, v141, v33, v51
    v_dot2_f32_bf16 v52, v138, v33, v52
    v_dot2_f32_bf16 v53, v142, v33, v53
    v_dot2_f32_bf16 v54, v139, v33, v54
    v_dot2_f32_bf16 v55, v143, v33, v55
    v_dot2_f32_bf16 v56, v136, v41, v56
    v_dot2_f32_bf16 v57, v140, v41, v57
    v_dot2_f32_bf16 v58, v137, v41, v58
    v_dot2_f32_bf16 v59, v141, v41, v59
    v_dot2_f32_bf16 v60, v138, v41, v60
    v_dot2_f32_bf16 v61, v142, v41, v61
    v_dot2_f32_bf16 v62, v139, v41, v62
    v_dot2_f32_bf16 v63, v143, v41, v63
    v_dot2_f32_bf16 v48, v144, v34, v48
    v_dot2_f32_bf16 v49, v148, v34, v49
    v_dot2_f32_bf16 v50, v145, v34, v50
    v_dot2_f32_bf16 v51, v149, v34, v51
    v_dot2_f32_bf16 v52, v146, v34, v52
    v_dot2_f32_bf16 v53, v150, v34, v53
    v_dot2_f32_bf16 v54, v147, v34, v54
    v_dot2_f32_bf16 v55, v151, v34, v55
    v_dot2_f32_bf16 v56, v144, v42, v56
    v_dot2_f32_bf16 v57, v148, v42, v57
    v_dot2_f32_bf16 v58, v145, v42, v58
    v_dot2_f32_bf16 v59, v149, v42, v59
    v_dot2_f32_bf16 v60, v146, v42, v60
    v_dot2_f32_bf16 v61, v150, v42, v61
    v_dot2_f32_bf16 v62, v147, v42, v62
    v_dot2_f32_bf16 v63, v151, v42, v63
    v_dot2_f32_bf16 v48, v152, v35, v48
    v_dot2_f32_bf16 v49, v156, v35, v49
    v_dot2_f32_bf16 v50, v153, v35, v50
    v_dot2_f32_bf16 v51, v157, v35, v51
    v_dot2_f32_bf16 v52, v154, v35, v52
    v_dot2_f32_bf16 v53, v158, v35, v53
    v_dot2_f32_bf16 v54, v155, v35, v54
    v_dot2_f32_bf16 v55, v159, v35, v55
    v_dot2_f32_bf16 v56, v152, v43, v56
    v_dot2_f32_bf16 v57, v156, v43, v57
    v_dot2_f32_bf16 v58, v153, v43, v58
    v_dot2_f32_bf16 v59, v157, v43, v59
    v_dot2_f32_bf16 v60, v154, v43, v60
    v_dot2_f32_bf16 v61, v158, v43, v61
    v_dot2_f32_bf16 v62, v155, v43, v62
    v_dot2_f32_bf16 v63, v159, v43, v63
    v_dot2_f32_bf16 v48, v160, v36, v48
    v_dot2_f32_bf16 v49, v164, v36, v49
    v_dot2_f32_bf16 v50, v161, v36, v50
    v_dot2_f32_bf16 v51, v165, v36, v51
    v_dot2_f32_bf16 v52, v162, v36, v52
    v_dot2_f32_bf16 v53, v166, v36, v53
    v_dot2_f32_bf16 v54, v163, v36, v54
    v_dot2_f32_bf16 v55, v167, v36, v55
    v_dot2_f32_bf16 v56, v160, v44, v56
    v_dot2_f32_bf16 v57, v164, v44, v57
    v_dot2_f32_bf16 v58, v161, v44, v58
    v_dot2_f32_bf16 v59, v165, v44, v59
    v_dot2_f32_bf16 v60, v162, v44, v60
    v_dot2_f32_bf16 v61, v166, v44, v61
    v_dot2_f32_bf16 v62, v163, v44, v62
    v_dot2_f32_bf16 v63, v167, v44, v63
    v_dot2_f32_bf16 v48, v168, v37, v48
    v_dot2_f32_bf16 v49, v172, v37, v49
    v_dot2_f32_bf16 v50, v169, v37, v50
    v_dot2_f32_bf16 v51, v173, v37, v51
    v_dot2_f32_bf16 v52, v170, v37, v52
    v_dot2_f32_bf16 v53, v174, v37, v53
    v_dot2_f32_bf16 v54, v171, v37, v54
    v_dot2_f32_bf16 v55, v175, v37, v55
    v_dot2_f32_bf16 v56, v168, v45, v56
    v_dot2_f32_bf16 v57, v172, v45, v57
    v_dot2_f32_bf16 v58, v169, v45, v58
    v_dot2_f32_bf16 v59, v173, v45, v59
    v_dot2_f32_bf16 v60, v170, v45, v60
    v_dot2_f32_bf16 v61, v174, v45, v61
    v_dot2_f32_bf16 v62, v171, v45, v62
    v_dot2_f32_bf16 v63, v175, v45, v63
    v_dot2_f32_bf16 v48, v176, v38, v48
    v_dot2_f32_bf16 v49, v180, v38, v49
    v_dot2_f32_bf16 v50, v177, v38, v50
    v_dot2_f32_bf16 v51, v181, v38, v51
    v_dot2_f32_bf16 v52, v178, v38, v52
    v_dot2_f32_bf16 v53, v182, v38, v53
    v_dot2_f32_bf16 v54, v179, v38, v54
    v_dot2_f32_bf16 v55, v183, v38, v55
    v_dot2_f32_bf16 v56, v176, v46, v56
    v_dot2_f32_bf16 v57, v180, v46, v57
    v_dot2_f32_bf16 v58, v177, v46, v58
    v_dot2_f32_bf16 v59, v181, v46, v59
    v_dot2_f32_bf16 v60, v178, v46, v60
    v_dot2_f32_bf16 v61, v182, v46, v61
    v_dot2_f32_bf16 v62, v179, v46, v62
    v_dot2_f32_bf16 v63, v183, v46, v63
    v_dot2_f32_bf16 v48, v184, v39, v48
    v_dot2_f32_bf16 v49, v188, v39, v49
    v_dot2_f32_bf16 v50, v185, v39, v50
    v_dot2_f32_bf16 v51, v189, v39, v51
    v_dot2_f32_bf16 v52, v186, v39, v52
    v_dot2_f32_bf16 v53, v190, v39, v53
    v_dot2_f32_bf16 v54, v187, v39, v54
    v_dot2_f32_bf16 v55, v191, v39, v55
    v_dot2_f32_bf16 v56, v184, v47, v56
    v_dot2_f32_bf16 v57, v188, v47, v57
    v_dot2_f32_bf16 v58, v185, v47, v58
    v_dot2_f32_bf16 v59, v189, v47, v59
    v_dot2_f32_bf16 v60, v186, v47, v60
    v_dot2_f32_bf16 v61, v190, v47, v61
    v_dot2_f32_bf16 v62, v187, v47, v62
    v_dot2_f32_bf16 v63, v191, v47, v63
    s_sub_u32 s32, s7, 128
L_YPUB:
    s_nop 3
    s_mul_i32 s98, s3, 3584
    s_add_u32 s98, s98, 32768
    v_lshlrev_b32 v12, 5, v1
    v_add_u32 v12, s98, v12
    s_mov_b32 exec_hi, 0x00ffffff
    ds_write_b128 v12, v[48:51] offset:0
    ds_write_b128 v12, v[52:55] offset:16
    ds_write_b128 v12, v[56:59] offset:1792
    ds_write_b128 v12, v[60:63] offset:1808
    s_mov_b32 exec_hi, -1
    s_waitcnt lgkmcnt(0)
    s_barrier
    v_cmp_gt_u32 vcc, 224, v0
    s_and_saveexec_b64 s[80:81], vcc
    s_cbranch_execz YS_69
    v_lshlrev_b32 v12, 4, v0
    v_add_u32 v13, 32768, v12
    ds_read_b128 v[64:67], v13 offset:0
    ds_read_b128 v[68:71], v13 offset:3584
    ds_read_b128 v[72:75], v13 offset:7168
    ds_read_b128 v[76:79], v13 offset:10752
    ds_read_b128 v[80:83], v13 offset:14336
    ds_read_b128 v[84:87], v13 offset:17920
    ds_read_b128 v[88:91], v13 offset:21504
    ds_read_b128 v[92:95], v13 offset:25088
    s_waitcnt lgkmcnt(0)
    v_add_f32 v64, v64, v68
    v_add_f32 v65, v65, v69
    v_add_f32 v66, v66, v70
    v_add_f32 v67, v67, v71
    v_add_f32 v64, v64, v72
    v_add_f32 v65, v65, v73
    v_add_f32 v66, v66, v74
    v_add_f32 v67, v67, v75
    v_add_f32 v64, v64, v76
    v_add_f32 v65, v65, v77
    v_add_f32 v66, v66, v78
    v_add_f32 v67, v67, v79
    v_add_f32 v64, v64, v80
    v_add_f32 v65, v65, v81
    v_add_f32 v66, v66, v82
    v_add_f32 v67, v67, v83
    v_add_f32 v64, v64, v84
    v_add_f32 v65, v65, v85
    v_add_f32 v66, v66, v86
    v_add_f32 v67, v67, v87
    v_add_f32 v64, v64, v88
    v_add_f32 v65, v65, v89
    v_add_f32 v66, v66, v90
    v_add_f32 v67, v67, v91
    v_add_f32 v64, v64, v92
    v_add_f32 v65, v65, v93
    v_add_f32 v66, v66, v94
    v_add_f32 v67, v67, v95
    s_mul_i32 s98, s32, 7168
    s_add_u32 s98, s98, 851968
    v_lshlrev_b32 v12, 5, v0
    v_mov_b32 v72, v64
    v_mov_b32 v73, s4
    v_mov_b32 v74, v65
    v_mov_b32 v75, s4
    v_mov_b32 v76, v66
    v_mov_b32 v77, s4
    v_mov_b32 v78, v67
    v_mov_b32 v79, s4
    buffer_store_dwordx4 v[72:75], v12, s[60:63], s98 offen sc1
    buffer_store_dwordx4 v[76:79], v12, s[60:63], s98 offen offset:16 sc1
YS_69:
    s_mov_b64 exec, s[80:81]
    s_cmp_lg_u32 s3, 0
    s_cbranch_scc1 FLAG_70
    s_sub_u32 s98, s32, 0
    s_lshl_b32 s98, s98, 2
    s_add_u32 s98, s98, 794624
    v_mov_b32 v13, s4
    s_mov_b64 exec, 1
    buffer_store_dword v13, off, s[60:63], s98 sc1
    s_mov_b64 exec, -1
FLAG_70:
    s_branch L_END
L_FINAL:
    s_lshl_b32 s32, s5, 2
    s_add_u32 s32, s32, s6
    s_sub_u32 s32, s32, 4
    s_cmp_ge_u32 s32, 56
    s_cbranch_scc1 L_END
    s_cmp_lg_u32 s3, 0
    s_cbranch_scc1 POLLOK_72
    v_lshlrev_b32 v12, 4, v1
    s_mov_b32 s98, 794624
    s_mov_b32 exec_lo, 0xffffffff
    s_mov_b32 exec_hi, 0x0
    s_mov_b32 s75, 0
POLL_71:
    buffer_load_dwordx4 v[88:91], v12, s[60:63], s98 offen sc1
    s_waitcnt vmcnt(0)
    v_cmp_eq_u32 vcc, s4, v88
    v_cmp_eq_u32 s[78:79], s4, v89
    s_and_b64 vcc, vcc, s[78:79]
    v_cmp_eq_u32 s[78:79], s4, v90
    s_and_b64 vcc, vcc, s[78:79]
    v_cmp_eq_u32 s[78:79], s4, v91
    s_and_b64 vcc, vcc, s[78:79]
    s_cmp_eq_u64 vcc, exec
    s_cbranch_scc1 POLLOK_72
    s_add_u32 s75, s75, 1
    s_cmp_gt_u32 s75, 400000
    s_cbranch_scc1 POLLOK_72
    s_sleep 1
    s_branch POLL_71
POLLOK_72:
    s_mov_b64 exec, -1
    s_barrier
    s_mov_b32 s98, s32
    s_cmp_ge_u32 s98, 28
    s_cselect_b32 s99, 1, 0
    s_mul_i32 s100, s99, 28
    s_sub_u32 s98, s98, s100
    s_mul_i32 s100, s99, 3584
    s_lshl_b32 s101, s98, 7
    s_add_u32 s100, s100, s101
    s_add_u32 s100, s100, 851968
    v_lshrrev_b32 v12, 3, v0
    v_bfe_u32 v13, v0, 2, 1
    v_lshl_add_u32 v12, v13, 6, v12
    s_movk_i32 s101, 7168
    v_mul_lo_u32 v12, v12, s101
    v_and_b32 v13, 3, v0
    v_lshl_add_u32 v12, v13, 5, v12
    s_mov_b32 s75, 0
FL_73:
    buffer_load_dwordx4 v[40:43], v12, s[60:63], s100 offen sc1
    buffer_load_dwordx4 v[44:47], v12, s[60:63], s100 offen offset:16 sc1
    s_waitcnt vmcnt(0)
    v_xor_b32 v13, s4, v41
    v_xor_b32 v14, s4, v43
    v_or_b32 v13, v13, v14
    v_xor_b32 v14, s4, v45
    v_or_b32 v13, v13, v14
    v_xor_b32 v14, s4, v47
    v_or_b32 v13, v13, v14
    v_cmp_eq_u32 vcc, 0, v13
    s_cmp_eq_u64 vcc, exec
    s_cbranch_scc1 FOK_74
    s_add_u32 s75, s75, 1
    s_cmp_gt_u32 s75, 400000
    s_cbranch_scc0 FL_73
FOK_74:
    v_mov_b32 v32, v40
    v_mov_b32 v33, v42
    v_mov_b32 v34, v44
    v_mov_b32 v35, v46
    s_nop 1
    v_add_f32_dpp v32, v32, v32 row_ror:8 row_mask:0xf bank_mask:0xf
    v_add_f32_dpp v33, v33, v33 row_ror:8 row_mask:0xf bank_mask:0xf
    v_add_f32_dpp v34, v34, v34 row_ror:8 row_mask:0xf bank_mask:0xf
    v_add_f32_dpp v35, v35, v35 row_ror:8 row_mask:0xf bank_mask:0xf
    v_mov_b32 v13, v32
    s_nop 1
    v_permlane16_swap_b32 v13, v32
    s_nop 1
    v_add_f32 v32, v32, v13
    v_mov_b32 v13, v32
    s_nop 1
    v_permlane32_swap_b32 v13, v32
    s_nop 1
    v_add_f32 v32, v32, v13
    v_mov_b32 v13, v33
    s_nop 1
    v_permlane16_swap_b32 v13, v33
    s_nop 1
    v_add_f32 v33, v33, v13
    v_mov_b32 v13, v33
    s_nop 1
    v_permlane32_swap_b32 v13, v33
    s_nop 1
    v_add_f32 v33, v33, v13
    v_mov_b32 v13, v34
    s_nop 1
    v_permlane16_swap_b32 v13, v34
    s_nop 1
    v_add_f32 v34, v34, v13
    v_mov_b32 v13, v34
    s_nop 1
    v_permlane32_swap_b32 v13, v34
    s_nop 1
    v_add_f32 v34, v34, v13
    v_mov_b32 v13, v35
    s_nop 1
    v_permlane16_swap_b32 v13, v35
    s_nop 1
    v_add_f32 v35, v35, v13
    v_mov_b32 v13, v35
    s_nop 1
    v_permlane32_swap_b32 v13, v35
    s_nop 1
    v_add_f32 v35, v35, v13
    v_lshlrev_b32 v12, 4, v1
    s_lshl_b32 s101, s3, 7
    s_add_u32 s101, s101, 28672
    v_add_u32 v12, s101, v12
    s_mov_b64 exec, 0xff
    ds_write_b128 v12, v[32:35]
    s_mov_b64 exec, -1
    s_waitcnt lgkmcnt(0)
    s_barrier
    s_cmp_lg_u32 s3, 0
    s_cbranch_scc1 L_END
    v_and_b32 v12, 31, v1
    v_lshlrev_b32 v12, 2, v12
    ds_read_b32 v32, v12 offset:28672
    ds_read_b32 v33, v12 offset:28800
    ds_read_b32 v34, v12 offset:28928
    ds_read_b32 v35, v12 offset:29056
    ds_read_b32 v36, v12 offset:29184
    ds_read_b32 v37, v12 offset:29312
    ds_read_b32 v38, v12 offset:29440
    ds_read_b32 v39, v12 offset:29568
    s_waitcnt lgkmcnt(0)
    v_add_f32 v32, v32, v33
    v_add_f32 v32, v32, v34
    v_add_f32 v32, v32, v35
    v_add_f32 v32, v32, v36
    v_add_f32 v32, v32, v37
    v_add_f32 v32, v32, v38
    v_add_f32 v32, v32, v39
    v_cvt_pk_bf16_f32 v32, v32, v32
    s_movk_i32 s101, 896
    v_mul_lo_u32 v12, v3, s101
    v_lshl_add_u32 v12, v2, 1, v12
    s_mul_i32 s100, s99, 1792
    s_lshl_b32 s101, s98, 5
    s_add_u32 s100, s100, s101
    s_mov_b32 exec_lo, -1
    s_mov_b32 exec_hi, 0
    buffer_store_short v32, v12, s[64:67], s100 offen
    s_mov_b64 exec, -1
    s_cmp_lg_u32 s32, 0
    s_cbranch_scc1 L_END
    v_mov_b32 v13, s4
    s_mov_b64 exec, 1
    buffer_store_dword v13, off, s[60:63], 0 sc1
L_END:
    s_endpgm
.section .rodata,"a"
.p2align 6
.amdhsa_kernel concat_heads__mha_block_cached__compressed_kv_cla__decode_kernel
  .amdhsa_next_free_vgpr 256
  .amdhsa_next_free_sgpr 102
  .amdhsa_accum_offset 256
  .amdhsa_group_segment_fixed_size 0
  .amdhsa_kernarg_size 112
  .amdhsa_user_sgpr_count 2
  .amdhsa_user_sgpr_kernarg_segment_ptr 1
  .amdhsa_system_sgpr_workgroup_id_x 1
.end_amdhsa_kernel
```
